```python
import torch

def _softmax(x, axis=-1):
    return torch.softmax(x, dim=axis)
def _gelu(x):
    return torch.nn.functional.gelu(x, approximate="tanh")
def _silu(x):
    return torch.nn.functional.silu(x)
def _sigmoid(x):
    return torch.sigmoid(x)
def _layernorm(x, axis=-1, eps=1e-5):
    m = x.mean(dim=axis, keepdim=True)
    v = x.var(dim=axis, keepdim=True, unbiased=False)
    return (x - m) / torch.sqrt(v + eps)
def _scatter_add(tgt, idx, src, axis=0):
    return tgt.clone().index_add_(axis, idx, src)
def _segment_sum(src, seg, n):
    out = torch.zeros((n,) + src.shape[1:], dtype=src.dtype)
    return out.index_add_(0, seg, src)
def _pad(x, pw):
    flat = tuple(v for pair in reversed(pw) for v in pair)
    return torch.nn.functional.pad(x, flat)

kernel_name = 'sequential_preLN__linear_kernel_hedgehog__dense_activation_relu__prompt'

def setup_inputs():

    _w = (lambda a: (lambda t: t.to(torch.bfloat16) if t.is_floating_point() else t)(torch.as_tensor(a)))
    def _A_setup():
        B, S, D, H = 1, 2048, 640, 32
        Dh = D // H
        return {
            "x": _w((lambda *s: torch.randn(*s, dtype=torch.bfloat16) * 0.05)(B, S, D)),
            "wqkv": _w((lambda *s: torch.randn(*s, dtype=torch.bfloat16) * 0.2)(D, 3 * D)),
            "w_phi": _w((lambda *s: torch.randn(*s, dtype=torch.bfloat16) * 0.2)(H, Dh, Dh) * (Dh ** -0.5)),
            "wo": _w((lambda *s: torch.randn(*s, dtype=torch.bfloat16) * 0.05)(D, D)),
        }
    _A_in = _A_setup()

    def _B_setup():
        B, S, D, Dff = 1, 2048, 640, 1728
        return {
            "x": _w((lambda *s: torch.randn(*s, dtype=torch.bfloat16) * 0.05)(B, S, D)),
            "w1": _w((lambda *s: torch.randn(*s, dtype=torch.bfloat16) * 0.05)(D, Dff)),
            "w2": _w((lambda *s: torch.randn(*s, dtype=torch.bfloat16) * 0.05)(Dff, D)),
        }
    _B_in = _B_setup()

    return {
        "A_x": _A_in["x"],
        "A_wqkv": _A_in["wqkv"],
        "A_w_phi": _A_in["w_phi"],
        "A_wo": _A_in["wo"],
        "B_x": _B_in["x"],
        "B_w1": _B_in["w1"],
        "B_w2": _B_in["w2"],
    }

def reference(A_x, A_wqkv, A_w_phi, A_wo, B_x, B_w1, B_w2):
    def _A_ref(x, wqkv, w_phi, wo):
        B, S, D = x.shape
        H = 32; Dh = D // H
        qkv = (lambda x, *d: x.permute(*d))((x @ wqkv).reshape(B, S, 3, H, Dh), 2, 0, 3, 1, 4)
        q, k, v = qkv[0], qkv[1], qkv[2]
        pq = torch.einsum("bhsd,hdf->bhsf", q, w_phi)
        pk = torch.einsum("bhsd,hdf->bhsf", k, w_phi)
        phi_q = torch.concatenate([_softmax(pq, axis=-1), _softmax(-pq, axis=-1)], axis=-1)
        phi_k = torch.concatenate([_softmax(pk, axis=-1), _softmax(-pk, axis=-1)], axis=-1)
        kv = torch.einsum("bhsf,bhsd->bhfd", phi_k, v)
        z  = torch.einsum("bhsf->bhf", phi_k)
        num = torch.einsum("bhqf,bhfd->bhqd", phi_q, kv)
        den = torch.einsum("bhqf,bhf->bhq", phi_q, z)[..., None] + 1e-6
        o = num / den
        return (lambda x, *d: x.permute(*d))(o, 0, 2, 1, 3).reshape(B, S, D) @ wo

    def _B_ref(x, w1, w2):
        h = torch.einsum("bsd,df->bsf", x, w1)
        zero = torch.zeros_like(h)
        h = torch.maximum(h, zero)
        return torch.einsum("bsf,fd->bsd", h, w2)

    x = A_x
    h = x + _A_ref(_layernorm(x, axis=-1), A_wqkv, A_w_phi, A_wo)
    h2 = h + _B_ref(_layernorm(h, axis=-1), B_w1, B_w2)
    return h2
```

```asm
; @launch grid=(256,1,1) block=(256,1,1) lds=163840
.amdgcn_target "amdgcn-amd-amdhsa--gfx950"
.text
.globl sequential_preLN__linear_kernel_hedgehog__dense_activation_relu__prompt_kernel
.p2align 8
.type sequential_preLN__linear_kernel_hedgehog__dense_activation_relu__prompt_kernel,@function
sequential_preLN__linear_kernel_hedgehog__dense_activation_relu__prompt_kernel:
  s_cmp_ge_u32 s2, 256
  s_cbranch_scc1 L_exit
  s_load_dwordx16 s[8:23], s[0:1], 0
  s_load_dwordx4 s[24:27], s[0:1], 64
  v_and_b32 v1, 63, v0
  v_lshrrev_b32 v2, 6, v0
  s_and_b32 s52, s2, 7
  s_lshr_b32 s53, s2, 3
  v_readfirstlane_b32 s48, v2
  s_getpc_b64 s[58:59]
L_pc:
  s_sub_u32 s58, s58, L_pc - sequential_preLN__linear_kernel_hedgehog__dense_activation_relu__prompt_kernel
  s_subb_u32 s59, s59, 0
  s_lshr_b32 s60, s2, 3
  s_lshl_b32 s60, s60, 2
  s_add_u32 s60, s60, s48
  s_lshl_b32 s60, s60, 9
  v_lshl_add_u32 v37, v1, 3, s60
  v_min_u32 v37, L_end - sequential_preLN__linear_kernel_hedgehog__dense_activation_relu__prompt_kernel - 4, v37
  global_load_dword v209, v37, s[58:59]
  s_lshr_b32 s49, s52, 1
  s_lshl_b32 s49, s49, 2
  s_and_b32 s54, s53, 3
  s_add_u32 s49, s49, s54
  s_and_b32 s50, s52, 1
  s_lshl_b32 s50, s50, 3
  s_lshr_b32 s54, s53, 2
  s_add_u32 s50, s50, s54
  s_lshr_b32 s82, s52, 2
  s_lshl_b32 s82, s82, 3
  s_and_b32 s54, s53, 7
  s_add_u32 s82, s82, s54
  s_and_b32 s83, s52, 3
  s_lshl_b32 s83, s83, 2
  s_lshr_b32 s54, s53, 3
  s_add_u32 s83, s83, s54
  v_lshlrev_b32 v2, 4, v1
  s_mov_b32 s30, 268435456
  s_mov_b32 s31, 0x20000
  s_mov_b32 s34, 2621440
  s_mov_b32 s35, 0x20000
  s_mov_b32 s38, 2621440
  s_mov_b32 s39, 0x20000
  s_mov_b32 s43, 0x20000
  s_mov_b32 s46, 2211840
  s_mov_b32 s47, 0x20000
  s_mov_b32 s84, 0x3fb8aa3b
  s_mov_b32 s85, 0
  v_lshrrev_b32 v3, 3, v1
  v_and_b32 v4, 7, v1
  s_mov_b32 s79, 0x3f803f80
  s_lshl_b32 s64, s48, 12
  v_and_b32 v8, 15, v1
  v_min_u32 v8, 14, v8
  v_mul_u32_u24 v9, 52, v8
  v_lshrrev_b32 v9, 8, v9
  v_mul_u32_u24 v9, 1200, v9
  v_lshl_add_u32 v8, v8, 4, v9
  v_lshrrev_b32 v10, 4, v1
  s_mul_i32 s55, s48, 12
  v_add_u32 v9, s55, v10
  s_mul_i32 s61, s82, 153600
  s_mul_i32 s55, s83, 80
  s_add_u32 s61, s61, s55
  s_mul_i32 s62, s48, 3072
  s_mov_b32 m0, s62
  s_mov_b32 s42, 2457600
  s_movk_i32 s56, 3840
  s_lshl_b32 s63, s82, 4
  s_add_u32 s63, s63, s83
  s_mul_i32 s60, s63, 10240
  s_add_u32 s60, s60, s62
  s_mov_b32 s78, 0
  v_add_u32 v11, 0, v9
  v_min_u32 v11, 39, v11
  v_mad_u32_u24 v17, v11, s56, v8
  v_add_u32 v11, 4, v9
  v_min_u32 v11, 39, v11
  v_mad_u32_u24 v18, v11, s56, v8
  v_add_u32 v11, 8, v9
  v_min_u32 v11, 39, v11
  v_mad_u32_u24 v19, v11, s56, v8
  s_waitcnt lgkmcnt(0)
  s_mov_b32 s28, s26
  s_mov_b32 s29, s27
  s_mov_b32 s32, s8
  s_mov_b32 s33, s9
  s_mov_b32 s36, s22
  s_mov_b32 s37, s23
  s_add_u32 s44, s26, 18956288
  s_addc_u32 s45, s27, 0
  s_mov_b32 s56, 24358912
  buffer_load_dword v7, off, s[28:31], s56 sc1
  s_mov_b32 s40, s10
  s_mov_b32 s41, s11
  buffer_load_dwordx4 v17, s[40:43], s61 offen lds
  s_add_u32 m0, m0, 1024
  s_nop 0
  buffer_load_dwordx4 v18, s[40:43], s61 offen lds
  s_add_u32 m0, m0, 1024
  s_nop 0
  buffer_load_dwordx4 v19, s[40:43], s61 offen lds
  s_add_u32 m0, s62, 16384
  s_mov_b32 s40, s12
  buffer_load_dwordx4 v2, s[32:35], s60 offen offset:0 lds
  buffer_load_dwordx4 v2, s[32:35], s60 offen offset:1024 lds
  buffer_load_dwordx4 v2, s[32:35], s60 offen offset:2048 lds
  s_mov_b32 s41, s13
  s_mov_b32 s42, 25600
  s_mul_i32 s61, s83, 1600
  s_mov_b32 m0, 12288
  v_mov_b32 v32, 0
  v_mov_b32 v33, 0
  v_mov_b32 v34, 0
  v_mov_b32 v35, 0
  v_add_u32 v36, 14336, v2
  buffer_load_dwordx4 v2, s[40:43], s61 offen lds
  buffer_load_dwordx4 v2, s[40:43], s61 offen offset:1024 lds
  ds_write_b128 v36, v[32:35]
  v_xor_b32 v94, v4, v10
  v_mul_u32_u24 v95, 1280, v3
  v_lshl_add_u32 v94, v94, 4, v95
  v_xor_b32 v95, 64, v94
  s_lshl_b32 s77, s82, 2
  s_add_u32 s77, s77, s48
  s_mul_i32 s77, s77, 40960
  v_and_b32 v10, 1, v10
  v_lshlrev_b32 v10, 2, v10
  v_xor_b32 v10, v4, v10
  v_lshlrev_b32 v205, 4, v10
  s_lshl_b32 s65, s2, 2
  s_add_u32 s65, s65, s48
  v_bfe_u32 v206, v1, 3, 2
  v_lshrrev_b32 v207, 5, v1
  s_cmp_ge_u32 s65, 864
  s_cbranch_scc1 L_swo_2
  s_cmp_lt_u32 s65, 432
  s_cselect_b32 s40, s18, s20
  s_cselect_b32 s41, s19, s21
  s_mov_b32 s42, 2211840
  s_mov_b32 s60, 1280
  s_cselect_b32 s60, 3456, s60
  s_mov_b32 s71, 55296
  s_cselect_b32 s71, 20480, s71
  s_cselect_b32 s55, 0, 432
  s_mov_b32 s56, 19419
  s_cselect_b32 s56, 52429, s56
  s_mov_b32 s57, 216
  s_cselect_b32 s57, 80, s57
  s_mov_b32 s73, 3440640
  s_cselect_b32 s73, 18956288, s73
  s_sub_u32 s74, s65, s55
  s_and_b32 s58, s74, 15
  s_mul_i32 s58, s58, 6912
  s_lshr_b32 s59, s74, 4
  s_lshl_b32 s59, s59, 8
  s_add_u32 s58, s58, s59
  s_add_u32 s72, s58, 24182784
  s_mul_i32 s74, s74, 5
  v_mad_u32_u24 v206, v206, s60, v205
  s_lshl_b32 s75, s71, 2
  s_lshl_b32 s60, s60, 2
  s_cmp_lt_u32 s65, 432
  s_cselect_b32 s13, 52, 37
  s_cselect_b32 s14, 5, 7
  s_cselect_b32 s15, 2, 3
  s_mul_i32 s58, s74, s56
  s_lshr_b32 s58, s58, 22
  s_mul_i32 s59, s58, s57
  s_sub_u32 s59, s74, s59
  s_mul_i32 s66, s58, s75
  s_lshl_b32 s55, s59, 8
  s_add_u32 s55, s55, s73
  s_add_u32 s66, s66, s55
  s_and_b32 s55, s59, 3
  s_lshr_b32 s59, s59, 2
  s_mul_i32 s86, s59, s13
  s_lshr_b32 s86, s86, 8
  s_mul_i32 s86, s86, s14
  s_sub_u32 s86, s59, s86
  s_cmp_eq_u32 s86, s15
  s_cselect_b32 s86, 1, 0
  s_cselect_b32 s87, 1, 4
  s_lshl_b32 s55, s55, s86
  s_lshl3_add_u32 s59, s59, s55
  s_mul_i32 s59, s59, s60
  s_mul_i32 s87, s87, s60
  s_lshl_b32 s58, s58, 7
  s_add_u32 s8, s59, s58
  v_mad_u32_u24 v210, v207, s87, v206
  s_add_u32 s74, s74, 1
  s_mul_i32 s58, s74, s56
  s_lshr_b32 s58, s58, 22
  s_mul_i32 s59, s58, s57
  s_sub_u32 s59, s74, s59
  s_mul_i32 s67, s58, s75
  s_lshl_b32 s55, s59, 8
  s_add_u32 s55, s55, s73
  s_add_u32 s67, s67, s55
  s_and_b32 s55, s59, 3
  s_lshr_b32 s59, s59, 2
  s_mul_i32 s86, s59, s13
  s_lshr_b32 s86, s86, 8
  s_mul_i32 s86, s86, s14
  s_sub_u32 s86, s59, s86
  s_cmp_eq_u32 s86, s15
  s_cselect_b32 s86, 1, 0
  s_cselect_b32 s87, 1, 4
  s_lshl_b32 s55, s55, s86
  s_lshl3_add_u32 s59, s59, s55
  s_mul_i32 s59, s59, s60
  s_mul_i32 s87, s87, s60
  s_lshl_b32 s58, s58, 7
  s_add_u32 s9, s59, s58
  v_mad_u32_u24 v214, v207, s87, v206
  s_add_u32 s74, s74, 1
  s_mul_i32 s58, s74, s56
  s_lshr_b32 s58, s58, 22
  s_mul_i32 s59, s58, s57
  s_sub_u32 s59, s74, s59
  s_mul_i32 s68, s58, s75
  s_lshl_b32 s55, s59, 8
  s_add_u32 s55, s55, s73
  s_add_u32 s68, s68, s55
  s_and_b32 s55, s59, 3
  s_lshr_b32 s59, s59, 2
  s_mul_i32 s86, s59, s13
  s_lshr_b32 s86, s86, 8
  s_mul_i32 s86, s86, s14
  s_sub_u32 s86, s59, s86
  s_cmp_eq_u32 s86, s15
  s_cselect_b32 s86, 1, 0
  s_cselect_b32 s87, 1, 4
  s_lshl_b32 s55, s55, s86
  s_lshl3_add_u32 s59, s59, s55
  s_mul_i32 s59, s59, s60
  s_mul_i32 s87, s87, s60
  s_lshl_b32 s58, s58, 7
  s_add_u32 s10, s59, s58
  v_mad_u32_u24 v218, v207, s87, v206
  s_add_u32 s74, s74, 1
  s_mul_i32 s58, s74, s56
  s_lshr_b32 s58, s58, 22
  s_mul_i32 s59, s58, s57
  s_sub_u32 s59, s74, s59
  s_mul_i32 s69, s58, s75
  s_lshl_b32 s55, s59, 8
  s_add_u32 s55, s55, s73
  s_add_u32 s69, s69, s55
  s_and_b32 s55, s59, 3
  s_lshr_b32 s59, s59, 2
  s_mul_i32 s86, s59, s13
  s_lshr_b32 s86, s86, 8
  s_mul_i32 s86, s86, s14
  s_sub_u32 s86, s59, s86
  s_cmp_eq_u32 s86, s15
  s_cselect_b32 s86, 1, 0
  s_cselect_b32 s87, 1, 4
  s_lshl_b32 s55, s55, s86
  s_lshl3_add_u32 s59, s59, s55
  s_mul_i32 s59, s59, s60
  s_mul_i32 s87, s87, s60
  s_lshl_b32 s58, s58, 7
  s_add_u32 s11, s59, s58
  v_mad_u32_u24 v222, v207, s87, v206
  s_add_u32 s74, s74, 1
  s_mul_i32 s58, s74, s56
  s_lshr_b32 s58, s58, 22
  s_mul_i32 s59, s58, s57
  s_sub_u32 s59, s74, s59
  s_mul_i32 s70, s58, s75
  s_lshl_b32 s55, s59, 8
  s_add_u32 s55, s55, s73
  s_add_u32 s70, s70, s55
  s_and_b32 s55, s59, 3
  s_lshr_b32 s59, s59, 2
  s_mul_i32 s86, s59, s13
  s_lshr_b32 s86, s86, 8
  s_mul_i32 s86, s86, s14
  s_sub_u32 s86, s59, s86
  s_cmp_eq_u32 s86, s15
  s_cselect_b32 s86, 1, 0
  s_cselect_b32 s87, 1, 4
  s_lshl_b32 s55, s55, s86
  s_lshl3_add_u32 s59, s59, s55
  s_mul_i32 s59, s59, s60
  s_mul_i32 s87, s87, s60
  s_lshl_b32 s58, s58, 7
  s_add_u32 s12, s59, s58
  v_mad_u32_u24 v226, v207, s87, v206
  s_add_u32 s74, s74, 1
  s_branch L_send_3
L_swo_2:
  s_mov_b32 s40, s14
  s_mov_b32 s41, s15
  s_mov_b32 s42, 819200
  s_mov_b32 s71, 20480
  s_sub_u32 s74, s65, 864
  s_lshr_b32 s58, s74, 4
  s_and_b32 s59, s74, 15
  s_mul_i32 s66, s58, 81920
  s_mul_i32 s55, s59, 1280
  s_add_u32 s66, s66, s55
  s_add_u32 s66, s66, 2621440
  s_mul_i32 s8, s59, 51200
  s_lshl_b32 s58, s58, 7
  s_add_u32 s8, s8, s58
  v_mul_u32_u24 v206, 1280, v206
  v_add_u32 v206, v206, v205
  v_mul_u32_u24 v207, 5120, v207
  v_mad_u32_u24 v210, v207, 1, v206
  v_mad_u32_u24 v214, v207, 1, v206
  s_add_u32 s9, s8, 10240
  s_add_u32 s67, s66, 256
  v_mad_u32_u24 v218, v207, 5, v206
  s_add_u32 s10, s8, 20480
  s_add_u32 s68, s66, 512
  v_mad_u32_u24 v222, v207, 1, v206
  s_add_u32 s11, s8, 25600
  s_add_u32 s69, s66, 768
  v_mad_u32_u24 v226, v207, 1, v206
  s_add_u32 s12, s8, 35840
  s_add_u32 s70, s66, 1024
L_send_3:
  v_lshrrev_b32 v207, 4, v1
  v_and_b32 v204, 15, v1
  v_lshlrev_b32 v204, 4, v204
  v_mad_u32_u24 v203, v207, s71, v204
  v_lshlrev_b32 v204, 2, v1
  s_mul_i32 s55, s48, 5120
  s_add_u32 s55, s55, 32768
  v_add_u32 v207, s55, v2
  v_bfe_u32 v17, v1, 2, 2
  v_lshrrev_b32 v18, 5, v1
  v_lshl_add_u32 v17, v18, 3, v17
  v_lshlrev_b32 v17, 8, v17
  v_bfe_u32 v19, v1, 4, 1
  v_bfe_u32 v20, v1, 1, 1
  v_lshl_add_u32 v19, v19, 1, v20
  v_and_b32 v20, 1, v1
  v_mul_u32_u24 v20, 40, v20
  v_add_u32 v17, v17, v20
  s_add_u32 s55, s48, 1
  s_and_b32 s55, s55, 3
  s_mul_i32 s55, s55, 80
  v_lshl_add_u32 v21, v19, 3, s55
  v_min_u32 v19, 2, v19
  v_mul_u32_u24 v22, 80, v19
  v_add_u32 v22, 32, v22
  s_cmp_eq_u32 s48, 2
  s_cselect_b64 vcc, -1, 0
  v_cndmask_b32 v21, v21, v22, vcc
  v_add_u32 v21, v17, v21
  v_and_b32 v19, 31, v1
  v_lshlrev_b32 v23, 2, v19
  v_lshlrev_b32 v19, 4, v19
  s_lshl_b32 s86, s48, 10
  s_mov_b32 s87, 3072
  s_cmp_eq_u32 s48, 3
  s_cselect_b32 s86, 122880, s86
  s_cselect_b32 s87, 1024, s87
  s_mul_i32 s55, s83, 163840
  s_add_u32 s86, s86, s55
  s_lshl_b32 s90, s83, 4
  s_add_u32 s90, s90, s82
  s_lshl_b32 s90, s90, 2
  s_add_u32 s90, s90, s48
  s_lshl_b32 s90, s90, 7
  s_add_u32 s90, s90, 24051712
  s_mul_i32 s55, s82, 5
  v_add_u32 v18, s55, v18
  v_add_u32 v20, 0, v18
  v_and_b32 v22, 1, v20
  v_lshl_add_u32 v22, v22, 9, v19
  v_lshrrev_b32 v20, 1, v20
  v_mad_u32_u24 v24, v20, s87, v22
  v_add_u32 v20, 2, v18
  v_and_b32 v22, 1, v20
  v_lshl_add_u32 v22, v22, 9, v19
  v_lshrrev_b32 v20, 1, v20
  v_mad_u32_u24 v25, v20, s87, v22
  v_add_u32 v20, 4, v18
  v_and_b32 v22, 1, v20
  v_lshl_add_u32 v22, v22, 9, v19
  v_lshrrev_b32 v20, 1, v20
  v_mad_u32_u24 v26, v20, s87, v22
  v_lshrrev_b32 v12, 4, v1
  v_and_b32 v27, 3, v1
  v_lshlrev_b32 v27, 3, v27
  v_lshl_add_u32 v27, v12, 5, v27
  v_bfe_u32 v28, v1, 3, 1
  v_lshlrev_b32 v28, 6, v28
  v_xor_b32 v27, v27, v28
  v_bfe_u32 v28, v1, 2, 2
  v_lshl_add_u32 v5, v28, 7, v27
  s_mul_i32 s55, s48, 5120
  s_add_u32 s55, s55, 32768
  v_add_u32 v5, s55, v5
  v_mov_b32 v56, 0
  v_mov_b32 v57, 0
  v_mul_u32_u24 v60, 1280, v4
  s_mul_i32 s55, s48, 0
  s_add_u32 s55, s55, 80
  v_add_u32 v61, s55, v3
  v_lshl_add_u32 v60, v61, 4, v60
  s_lshr_b32 s55, s63, 2
  s_mul_i32 s60, s55, 40960
  s_and_b32 s55, s63, 3
  s_lshl_b32 s55, s55, 7
  s_add_u32 s60, s60, s55
  s_add_u32 s60, s60, 21168128
  v_mov_b32 v63, 0x7fffffff
  v_lshrrev_b32 v62, 5, v1
  s_lshl_b32 s55, s48, 1
  v_add_u32 v62, s55, v62
  v_and_b32 v68, 7, v1
  v_lshlrev_b32 v68, 3, v68
  v_lshl_add_u32 v68, v62, 6, v68
  v_mul_u32_u24 v62, 1280, v62
  v_and_b32 v63, 31, v1
  v_lshl_add_u32 v67, v63, 4, v62
  s_lshl_b32 s61, s63, 9
  s_add_u32 s61, s61, 23789568
  v_mov_b32 v92, 0
  v_mov_b32 v93, 0
  v_mov_b32 v88, 0
  v_mov_b32 v89, 0
  v_mov_b32 v90, 0
  v_mov_b32 v91, 0
  s_waitcnt vmcnt(0) lgkmcnt(0)
  s_barrier
  v_readfirstlane_b32 s51, v7
  s_nop 0
  s_add_u32 s51, s51, 16
  s_and_b32 s51, s51, -16
  ds_read_b64_tr_b16 v[32:33], v21 offset:0
  ds_read_b64_tr_b16 v[34:35], v21 offset:1024
  ds_read_b64_tr_b16 v[36:37], v21 offset:4096
  ds_read_b64_tr_b16 v[38:39], v21 offset:5120
  ds_read_b64_tr_b16 v[40:41], v21 offset:8192
  ds_read_b64_tr_b16 v[42:43], v21 offset:9216
  s_waitcnt lgkmcnt(4)
  buffer_store_dwordx4 v[32:35], v24, s[28:31], s86 offen sc1
  s_waitcnt lgkmcnt(2)
  buffer_store_dwordx4 v[36:39], v25, s[28:31], s86 offen sc1
  s_mov_b64 exec, 0xffffffff
  s_waitcnt lgkmcnt(0)
  buffer_store_dwordx4 v[40:43], v26, s[28:31], s86 offen sc1
  v_dot2c_f32_bf16 v56, s79, v40
  v_dot2c_f32_bf16 v57, s79, v41
  v_dot2c_f32_bf16 v56, s79, v42
  v_dot2c_f32_bf16 v57, s79, v43
  s_mov_b64 exec, -1
  v_dot2c_f32_bf16 v56, s79, v32
  v_dot2c_f32_bf16 v57, s79, v33
  v_dot2c_f32_bf16 v56, s79, v34
  v_dot2c_f32_bf16 v57, s79, v35
  v_dot2c_f32_bf16 v56, s79, v36
  v_dot2c_f32_bf16 v57, s79, v37
  v_dot2c_f32_bf16 v56, s79, v38
  v_dot2c_f32_bf16 v57, s79, v39
  s_nop 2
  v_add_f32 v56, v56, v57
  v_mov_b32 v58, v56
  s_nop 1
  v_permlane32_swap_b32 v56, v58
  v_add_f32 v56, v56, v58
  s_mov_b64 exec, 0xffffffff
  buffer_store_dword v56, v23, s[28:31], s90 offen sc1
  s_mov_b64 exec, -1
  ds_read_b128 v[80:83], v67 offset:16384
  ds_read_b128 v[84:87], v67 offset:16896
  s_mov_b32 exec_lo, 0xffff
  s_mov_b32 exec_hi, 0xffff
  ds_read_b128 v[88:91], v67 offset:17408
  s_mov_b64 exec, -1
  s_waitcnt lgkmcnt(0)
  v_dot2c_f32_bf16 v92, s79, v80
  v_dot2c_f32_bf16 v93, v80, v80
  v_dot2c_f32_bf16 v92, s79, v81
  v_dot2c_f32_bf16 v93, v81, v81
  v_dot2c_f32_bf16 v92, s79, v82
  v_dot2c_f32_bf16 v93, v82, v82
  v_dot2c_f32_bf16 v92, s79, v83
  v_dot2c_f32_bf16 v93, v83, v83
  v_dot2c_f32_bf16 v92, s79, v84
  v_dot2c_f32_bf16 v93, v84, v84
  v_dot2c_f32_bf16 v92, s79, v85
  v_dot2c_f32_bf16 v93, v85, v85
  v_dot2c_f32_bf16 v92, s79, v86
  v_dot2c_f32_bf16 v93, v86, v86
  v_dot2c_f32_bf16 v92, s79, v87
  v_dot2c_f32_bf16 v93, v87, v87
  v_dot2c_f32_bf16 v92, s79, v88
  v_dot2c_f32_bf16 v93, v88, v88
  v_dot2c_f32_bf16 v92, s79, v89
  v_dot2c_f32_bf16 v93, v89, v89
  v_dot2c_f32_bf16 v92, s79, v90
  v_dot2c_f32_bf16 v93, v90, v90
  v_dot2c_f32_bf16 v92, s79, v91
  v_dot2c_f32_bf16 v93, v91, v91
  s_nop 1
  v_add_f32_dpp v92, v92, v92 row_ror:1 row_mask:0xf bank_mask:0xf
  v_add_f32_dpp v93, v93, v93 row_ror:1 row_mask:0xf bank_mask:0xf
  s_nop 0
  v_add_f32_dpp v92, v92, v92 row_ror:2 row_mask:0xf bank_mask:0xf
  v_add_f32_dpp v93, v93, v93 row_ror:2 row_mask:0xf bank_mask:0xf
  s_nop 0
  v_add_f32_dpp v92, v92, v92 row_ror:4 row_mask:0xf bank_mask:0xf
  v_add_f32_dpp v93, v93, v93 row_ror:4 row_mask:0xf bank_mask:0xf
  s_nop 0
  v_add_f32_dpp v92, v92, v92 row_ror:8 row_mask:0xf bank_mask:0xf
  v_add_f32_dpp v93, v93, v93 row_ror:8 row_mask:0xf bank_mask:0xf
  v_mov_b32 v80, v92
  v_mov_b32 v81, v93
  s_nop 0
  v_permlane16_swap_b32 v92, v80
  v_permlane16_swap_b32 v93, v81
  v_add_f32 v92, v92, v80
  v_add_f32 v93, v93, v81
  v_mul_f32 v92, 0xbacccccd, v92
  v_mul_f32 v93, 0x3acccccd, v93
  v_fma_f32 v93, -v92, v92, v93
  v_max_f32 v93, 0, v93
  v_add_f32 v93, 0x3727c5ac, v93
  v_rsq_f32 v93, v93
  s_mov_b32 exec_lo, 0xff
  s_mov_b32 exec_hi, 0xff
  buffer_store_dwordx2 v[92:93], v68, s[28:31], s61 offen sc1
  s_mov_b64 exec, -1
  s_add_u32 m0, s64, 65536
  s_add_u32 s61, s77, 0
  buffer_load_dwordx4 v94, s[32:35], s61 offen lds
  s_add_u32 m0, m0, 1024
  s_add_u32 s61, s61, 10240
  buffer_load_dwordx4 v95, s[32:35], s61 offen lds
  s_add_u32 m0, m0, 1024
  s_add_u32 s61, s61, 10240
  buffer_load_dwordx4 v94, s[32:35], s61 offen lds
  s_add_u32 m0, m0, 1024
  s_add_u32 s61, s61, 10240
  buffer_load_dwordx4 v95, s[32:35], s61 offen lds
  s_add_u32 m0, s64, 81920
  s_add_u32 s61, s77, 128
  buffer_load_dwordx4 v94, s[32:35], s61 offen lds
  s_add_u32 m0, m0, 1024
  s_add_u32 s61, s61, 10240
  buffer_load_dwordx4 v95, s[32:35], s61 offen lds
  s_add_u32 m0, m0, 1024
  s_add_u32 s61, s61, 10240
  buffer_load_dwordx4 v94, s[32:35], s61 offen lds
  s_add_u32 m0, m0, 1024
  s_add_u32 s61, s61, 10240
  buffer_load_dwordx4 v95, s[32:35], s61 offen lds
  s_add_u32 m0, s64, 98304
  s_add_u32 s61, s77, 256
  buffer_load_dwordx4 v94, s[32:35], s61 offen lds
  s_add_u32 m0, m0, 1024
  s_add_u32 s61, s61, 10240
  buffer_load_dwordx4 v95, s[32:35], s61 offen lds
  s_add_u32 m0, m0, 1024
  s_add_u32 s61, s61, 10240
  buffer_load_dwordx4 v94, s[32:35], s61 offen lds
  s_add_u32 m0, m0, 1024
  s_add_u32 s61, s61, 10240
  buffer_load_dwordx4 v95, s[32:35], s61 offen lds
  buffer_load_dwordx4 v[210:213], v210, s[40:43], s8 offen
  buffer_load_dwordx4 v[214:217], v214, s[40:43], s9 offen
  buffer_load_dwordx4 v[218:221], v218, s[40:43], s10 offen
  buffer_load_dwordx4 v[222:225], v222, s[40:43], s11 offen
  buffer_load_dwordx4 v[226:229], v226, s[40:43], s12 offen
  v_and_b32 v192, 31, v1
  v_lshrrev_b32 v193, 5, v1
  s_lshl_b32 s90, s48, 5
  v_add_u32 v194, s90, v192
  v_lshl_add_u32 v194, v193, 7, v194
  v_lshlrev_b32 v194, 7, v194
  v_add_u32 v194, 90112, v194
  v_bfe_u32 v195, v1, 1, 1
  v_lshlrev_b32 v195, 2, v195
  v_bfe_u32 v196, v1, 2, 1
  v_lshl_add_u32 v195, v196, 1, v195
  v_and_b32 v196, 1, v1
  v_add_u32 v195, v195, v196
  v_lshl_add_u32 v246, v195, 4, v194
  v_mul_u32_u24 v194, 384, v193
  v_lshl_add_u32 v251, v192, 4, v194
  s_lshr_b32 s90, s48, 1
  s_and_b32 s6, s48, 1
  s_lshl_b32 s86, s90, 14
  s_add_u32 s86, s86, 90112
  v_bfe_u32 v192, v1, 2, 2
  v_lshl_add_u32 v192, v193, 3, v192
  v_lshlrev_b32 v192, 7, v192
  v_add_u32 v192, s86, v192
  v_and_b32 v194, 1, v1
  v_lshl_add_u32 v192, v194, 3, v192
  v_bfe_u32 v194, v1, 4, 1
  v_bfe_u32 v195, v1, 1, 1
  v_lshl_add_u32 v194, v194, 1, v195
  v_bfe_u32 v195, v1, 3, 1
  v_lshlrev_b32 v195, 2, v195
  v_bfe_u32 v196, v1, 2, 1
  v_add_u32 v195, v195, v196
  s_lshl_b32 s87, s6, 2
  v_add_u32 v196, s87, v194
  v_add_u32 v197, 5, v194
  v_min_u32 v197, 7, v197
  v_xor_b32 v196, v196, v195
  v_xor_b32 v197, v197, v195
  v_lshl_add_u32 v247, v196, 4, v192
  v_lshl_add_u32 v249, v197, 4, v192
  v_xor_b32 v196, 2, v196
  v_xor_b32 v197, 2, v197
  v_lshl_add_u32 v248, v196, 4, v192
  v_lshl_add_u32 v250, v197, 4, v192
  s_lshl_b32 s3, s83, 4
  s_add_u32 s3, s3, s82
  s_mul_i32 s3, s3, 3840
  s_mul_i32 s87, s90, 1920
  s_add_u32 s3, s3, s87
  s_mul_i32 s87, s6, 1536
  s_add_u32 s3, s3, s87
  s_add_u32 s3, s3, 5652480
  v_min_u32 v199, 239, v0
  v_lshlrev_b32 v252, 4, v199
  v_mul_u32_u24 v192, 2731, v199
  v_lshrrev_b32 v192, 16, v192
  v_mul_u32_u24 v193, 24, v192
  v_sub_u32 v193, v199, v193
  v_cmp_le_u32 s[90:91], 5, v192
  v_subrev_u32 v195, 5, v192
  s_nop 0
  v_cndmask_b32 v195, v192, v195, s[90:91]
  v_cndmask_b32 v196, 0, 1, s[90:91]
  v_lshrrev_b32 v197, 4, v193
  v_and_b32 v198, 15, v193
  v_mad_u32_u24 v195, v197, 5, v195
  v_lshlrev_b32 v195, 10, v195
  v_lshrrev_b32 v197, 2, v198
  v_lshlrev_b32 v197, 3, v197
  v_and_b32 v198, 3, v198
  v_add_u32 v197, v197, v198
  v_mad_u32_u24 v197, v196, 36, v197
  v_lshl_add_u32 v195, v197, 4, v195
  v_add_u32 v253, 153600, v195
  s_mul_i32 s4, s83, 61440
  s_add_u32 s4, s4, 5652480
  v_and_b32 v192, 15, v1
  v_bfe_u32 v193, v1, 4, 1
  v_lshrrev_b32 v194, 5, v1
  v_mul_u32_u24 v193, 20480, v193
  v_mul_u32_u24 v194, 768, v194
  v_lshl_add_u32 v192, v192, 4, v193
  v_add_u32 v254, v192, v194
  s_lshl_b32 s5, s82, 2
  s_add_u32 s5, s5, s48
  s_mul_i32 s5, s5, 40960
  s_mul_i32 s90, s83, 1280
  s_add_u32 s5, s5, s90
  s_add_u32 s5, s5, 6635520
  v_mul_u32_u24 v255, 40, v0
  v_add_u32 v255, 153600, v255
  s_mul_i32 s53, s83, 163840
  s_lshl_b32 s7, s48, 10
  s_add_u32 s53, s53, s7
  s_add_u32 s53, s53, 0
  s_sub_u32 s101, s53, s7
  s_add_u32 s101, s101, 122880
  s_lshl_b32 s90, s78, 12
  s_add_u32 s100, s53, s90
  s_add_u32 s100, s100, 122880
  s_mul_i32 s90, s78, 12288
  s_add_u32 s53, s53, s90
  s_lshl_b32 s54, s83, 13
  s_add_u32 s54, s54, 24051712
  s_lshl_b32 s90, s48, 11
  s_add_u32 s54, s54, s90
  s_lshl_b32 s90, s48, 9
  s_add_u32 s90, s90, 122880
  v_and_b32 v192, 31, v1
  v_lshlrev_b32 v235, 4, v192
  v_add_u32 v235, s90, v235
  v_lshlrev_b32 v240, 2, v192
  v_add_u32 v240, 122880, v240
  s_mul_i32 s88, s50, 143360
  s_add_u32 s44, s44, s88
  s_addc_u32 s45, s45, 0
  s_sub_u32 s46, s46, s88
  s_mov_b32 s89, s7
  s_lshr_b32 s90, s50, 1
  s_mul_i32 s92, s90, 102400
  s_mul_i32 s91, s48, 5120
  s_add_u32 s92, s92, s91
  s_add_u32 s92, s92, 2621440
  s_mul_i32 s52, s48, 14
  s_cmp_eq_u32 s48, 3
  s_cselect_b32 s52, 41, s52
  s_lshl_b32 s52, s52, 10
  s_mul_i32 s93, s90, 276480
  s_add_u32 s93, s93, s52
  s_add_u32 s93, s93, 3440640
  v_and_b32 v116, 31, v1
  v_lshrrev_b32 v117, 5, v1
  v_bfe_u32 v118, v1, 1, 3
  v_xor_b32 v117, v117, v118
  v_lshlrev_b32 v116, 7, v116
  v_add_u32 v116, s64, v116
  v_lshl_add_u32 v112, v117, 4, v116
  v_xor_b32 v113, 32, v112
  v_xor_b32 v114, 64, v112
  v_xor_b32 v115, 96, v112
  s_lshl_b32 s16, s82, 2
  s_add_u32 s16, s16, s48
  s_lshl_b32 s17, s16, 11
  s_add_u32 s17, s17, 23789568
  s_mul_i32 s16, s16, 40960
  s_add_u32 s16, s16, 21168128
  v_and_b32 v120, 31, v1
  v_lshlrev_b32 v120, 6, v120
  v_and_b32 v192, 31, v1
  v_lshrrev_b32 v193, 5, v1
  v_bfe_u32 v194, v1, 2, 1
  v_lshrrev_b32 v195, 3, v192
  v_and_b32 v196, 3, v1
  v_lshl_add_u32 v195, v195, 2, v196
  v_mul_u32_u24 v196, 800, v193
  v_lshl_add_u32 v196, v195, 1, v196
  v_mov_b32 v197, 2048
  v_cmp_eq_u32 s[90:91], v193, v194
  v_add_u32 v198, 32, v196
  s_nop 0
  v_cndmask_b32 v196, v197, v196, s[90:91]
  v_cndmask_b32 v198, v197, v198, s[90:91]
  v_cmp_gt_u32 s[90:91], 8, v192
  s_mov_b32 s86, 12288
  v_add_u32 v241, s86, v196
  v_cndmask_b32 v198, v197, v198, s[90:91]
  v_add_u32 v242, s86, v198
  ds_read_u16 v156, v241 offset:0
  ds_read_u16 v176, v242 offset:0
  ds_read_u16_d16_hi v157, v241 offset:40
  ds_read_u16_d16_hi v177, v242 offset:40
  ds_read_u16 v158, v241 offset:80
  ds_read_u16 v178, v242 offset:80
  ds_read_u16_d16_hi v159, v241 offset:120
  ds_read_u16_d16_hi v179, v242 offset:120
  ds_read_u16 v160, v241 offset:160
  ds_read_u16 v180, v242 offset:160
  ds_read_u16_d16_hi v161, v241 offset:200
  ds_read_u16_d16_hi v181, v242 offset:200
  ds_read_u16 v162, v241 offset:240
  ds_read_u16 v182, v242 offset:240
  ds_read_u16_d16_hi v163, v241 offset:280
  ds_read_u16_d16_hi v183, v242 offset:280
  ds_read_u16 v164, v241 offset:320
  ds_read_u16 v184, v242 offset:320
  ds_read_u16_d16_hi v165, v241 offset:360
  ds_read_u16_d16_hi v185, v242 offset:360
  ds_read_u16 v166, v241 offset:400
  ds_read_u16 v186, v242 offset:400
  ds_read_u16_d16_hi v167, v241 offset:440
  ds_read_u16_d16_hi v187, v242 offset:440
  ds_read_u16 v168, v241 offset:480
  ds_read_u16 v188, v242 offset:480
  ds_read_u16_d16_hi v169, v241 offset:520
  ds_read_u16_d16_hi v189, v242 offset:520
  ds_read_u16 v170, v241 offset:560
  ds_read_u16 v190, v242 offset:560
  ds_read_u16_d16_hi v171, v241 offset:600
  ds_read_u16_d16_hi v191, v242 offset:600
  ds_read_u16 v172, v241 offset:640
  ds_read_u16 v192, v242 offset:640
  ds_read_u16_d16_hi v173, v241 offset:680
  ds_read_u16_d16_hi v193, v242 offset:680
  ds_read_u16 v174, v241 offset:720
  ds_read_u16 v194, v242 offset:720
  ds_read_u16_d16_hi v175, v241 offset:760
  ds_read_u16_d16_hi v195, v242 offset:760
  s_waitcnt lgkmcnt(0)
  v_or_b32 v8, v156, v157
  v_or_b32 v20, v176, v177
  v_or_b32 v9, v158, v159
  v_or_b32 v21, v178, v179
  v_or_b32 v10, v160, v161
  v_or_b32 v22, v180, v181
  v_or_b32 v11, v162, v163
  v_or_b32 v23, v182, v183
  v_or_b32 v12, v164, v165
  v_or_b32 v24, v184, v185
  v_or_b32 v13, v166, v167
  v_or_b32 v25, v186, v187
  v_or_b32 v14, v168, v169
  v_or_b32 v26, v188, v189
  v_or_b32 v15, v170, v171
  v_or_b32 v27, v190, v191
  v_or_b32 v16, v172, v173
  v_or_b32 v28, v192, v193
  v_or_b32 v17, v174, v175
  v_or_b32 v29, v194, v195
  v_mov_b32 v18, 0
  v_mov_b32 v19, 0
  v_mov_b32 v30, 0
  v_mov_b32 v31, 0
  s_waitcnt vmcnt(17)
  s_barrier
  s_cmp_lg_u32 s48, 0
  s_cbranch_scc1 L_fl_1
  s_lshl_b32 s58, s83, 7
  s_lshl_b32 s59, s82, 2
  s_add_u32 s58, s58, s59
  s_lshl_b32 s59, s82, 7
  s_lshl_b32 s55, s83, 2
  s_add_u32 s59, s59, s55
  s_add_u32 s59, s59, 2048
  v_mov_b32 v6, s58
  v_mov_b32 v7, s51
  v_writelane_b32 v6, s59, 1
  s_mov_b32 s58, 24301568
  s_mov_b64 exec, 3
  buffer_store_dword v7, v6, s[28:31], s58 offen sc1
  s_mov_b64 exec, -1
L_fl_1:
  s_add_u32 m0, s64, 114688
  s_add_u32 s61, s77, 384
  buffer_load_dwordx4 v94, s[32:35], s61 offen lds
  s_add_u32 m0, m0, 1024
  s_add_u32 s61, s61, 10240
  buffer_load_dwordx4 v95, s[32:35], s61 offen lds
  s_add_u32 m0, m0, 1024
  s_add_u32 s61, s61, 10240
  buffer_load_dwordx4 v94, s[32:35], s61 offen lds
  s_add_u32 m0, m0, 1024
  s_add_u32 s61, s61, 10240
  buffer_load_dwordx4 v95, s[32:35], s61 offen lds
  s_add_u32 m0, s64, 131072
  s_add_u32 s61, s77, 512
  buffer_load_dwordx4 v94, s[32:35], s61 offen lds
  s_add_u32 m0, m0, 1024
  s_add_u32 s61, s61, 10240
  buffer_load_dwordx4 v95, s[32:35], s61 offen lds
  s_add_u32 m0, m0, 1024
  s_add_u32 s61, s61, 10240
  buffer_load_dwordx4 v94, s[32:35], s61 offen lds
  s_add_u32 m0, m0, 1024
  s_add_u32 s61, s61, 10240
  buffer_load_dwordx4 v95, s[32:35], s61 offen lds
  s_add_u32 m0, s64, 147456
  s_add_u32 s61, s77, 640
  buffer_load_dwordx4 v94, s[32:35], s61 offen lds
  s_add_u32 m0, m0, 1024
  s_add_u32 s61, s61, 10240
  buffer_load_dwordx4 v95, s[32:35], s61 offen lds
  s_add_u32 m0, m0, 1024
  s_add_u32 s61, s61, 10240
  buffer_load_dwordx4 v94, s[32:35], s61 offen lds
  s_add_u32 m0, m0, 1024
  s_add_u32 s61, s61, 10240
  buffer_load_dwordx4 v95, s[32:35], s61 offen lds
  s_waitcnt vmcnt(8)
  s_lshl_b32 s58, s83, 7
  s_lshl_b32 s59, s82, 7
  s_add_u32 s59, s59, 1984
  v_mov_b32 v6, s58
  v_mov_b32 v7, s59
  v_cmp_gt_u32 vcc, 16, v1
  v_and_b32 v60, 31, v1
  s_mov_b32 s58, 24301568
  v_cndmask_b32 v6, v7, v6, vcc
  v_lshl_add_u32 v6, v60, 2, v6
  v_add_u32 v116, 65536, v112
  v_add_u32 v117, 65536, v113
  v_add_u32 v118, 65536, v114
  v_add_u32 v119, 65536, v115
  ds_read_b128 a[0:3], v116 offset:0
  ds_read_b128 a[4:7], v117 offset:0
  ds_read_b128 a[8:11], v118 offset:0
  ds_read_b128 a[12:15], v119 offset:0
  ds_read_b128 a[16:19], v116 offset:16384
  ds_read_b128 a[20:23], v117 offset:16384
  ds_read_b128 a[24:27], v118 offset:16384
  ds_read_b128 a[28:31], v119 offset:16384
  ds_read_b128 a[32:35], v116 offset:32768
  ds_read_b128 a[36:39], v117 offset:32768
  ds_read_b128 a[40:43], v118 offset:32768
  ds_read_b128 a[44:47], v119 offset:32768
  ds_read_b128 a[48:51], v116 offset:49152
  ds_read_b128 a[52:55], v117 offset:49152
  ds_read_b128 a[56:59], v118 offset:49152
  ds_read_b128 a[60:63], v119 offset:49152
  s_waitcnt lgkmcnt(0)
  s_add_u32 m0, s64, 65536
  s_add_u32 s61, s77, 768
  buffer_load_dwordx4 v94, s[32:35], s61 offen lds
  s_add_u32 m0, m0, 1024
  s_add_u32 s61, s61, 10240
  buffer_load_dwordx4 v95, s[32:35], s61 offen lds
  s_add_u32 m0, m0, 1024
  s_add_u32 s61, s61, 10240
  buffer_load_dwordx4 v94, s[32:35], s61 offen lds
  s_add_u32 m0, m0, 1024
  s_add_u32 s61, s61, 10240
  buffer_load_dwordx4 v95, s[32:35], s61 offen lds
  s_add_u32 m0, s64, 81920
  s_add_u32 s61, s77, 896
  buffer_load_dwordx4 v94, s[32:35], s61 offen lds
  s_add_u32 m0, m0, 1024
  s_add_u32 s61, s61, 10240
  buffer_load_dwordx4 v95, s[32:35], s61 offen lds
  s_add_u32 m0, m0, 1024
  s_add_u32 s61, s61, 10240
  buffer_load_dwordx4 v94, s[32:35], s61 offen lds
  s_add_u32 m0, m0, 1024
  s_add_u32 s61, s61, 10240
  buffer_load_dwordx4 v95, s[32:35], s61 offen lds
  s_add_u32 m0, s64, 98304
  s_add_u32 s61, s77, 1024
  buffer_load_dwordx4 v94, s[32:35], s61 offen lds
  s_add_u32 m0, m0, 1024
  s_add_u32 s61, s61, 10240
  buffer_load_dwordx4 v95, s[32:35], s61 offen lds
  s_add_u32 m0, m0, 1024
  s_add_u32 s61, s61, 10240
  buffer_load_dwordx4 v94, s[32:35], s61 offen lds
  s_add_u32 m0, m0, 1024
  s_add_u32 s61, s61, 10240
  buffer_load_dwordx4 v95, s[32:35], s61 offen lds
  s_add_u32 m0, s64, 114688
  s_add_u32 s61, s77, 1152
  buffer_load_dwordx4 v94, s[32:35], s61 offen lds
  s_add_u32 m0, m0, 1024
  s_add_u32 s61, s61, 10240
  buffer_load_dwordx4 v95, s[32:35], s61 offen lds
  s_add_u32 m0, m0, 1024
  s_add_u32 s61, s61, 10240
  buffer_load_dwordx4 v94, s[32:35], s61 offen lds
  s_add_u32 m0, m0, 1024
  s_add_u32 s61, s61, 10240
  buffer_load_dwordx4 v95, s[32:35], s61 offen lds
  s_waitcnt vmcnt(28)
  ds_write_b128 v207, v[210:213] offset:0
  ds_write_b128 v207, v[214:217] offset:1024
  ds_write_b128 v207, v[218:221] offset:2048
  ds_write_b128 v207, v[222:225] offset:3072
  ds_write_b128 v207, v[226:229] offset:4096
  s_waitcnt lgkmcnt(0)
  ds_read_b64_tr_b16 v[210:211], v5 offset:0
  ds_read_b64_tr_b16 v[212:213], v5 offset:512
  ds_read_b64_tr_b16 v[214:215], v5 offset:1024
  ds_read_b64_tr_b16 v[216:217], v5 offset:1536
  ds_read_b64_tr_b16 v[218:219], v5 offset:2048
  ds_read_b64_tr_b16 v[220:221], v5 offset:2560
  ds_read_b64_tr_b16 v[222:223], v5 offset:3072
  ds_read_b64_tr_b16 v[224:225], v5 offset:3584
  ds_read_b64_tr_b16 v[226:227], v5 offset:4096
  ds_read_b64_tr_b16 v[228:229], v5 offset:4608
  buffer_load_dword v7, v6, s[28:31], s58 offen sc1
  s_waitcnt lgkmcnt(8)
  buffer_store_dwordx4 v[210:213], v203, s[28:31], s66 offen sc1
  s_waitcnt lgkmcnt(6)
  buffer_store_dwordx4 v[214:217], v203, s[28:31], s67 offen sc1
  s_waitcnt lgkmcnt(4)
  buffer_store_dwordx4 v[218:221], v203, s[28:31], s68 offen sc1
  s_waitcnt lgkmcnt(2)
  buffer_store_dwordx4 v[222:225], v203, s[28:31], s69 offen sc1
  s_waitcnt lgkmcnt(0)
  buffer_store_dwordx4 v[226:229], v203, s[28:31], s70 offen sc1
  s_cmp_ge_u32 s65, 432
  s_cbranch_scc1 L_nocs_4
  v_mov_b32 v176, 0
  v_mov_b32 v177, 0
  v_dot2c_f32_bf16 v176, s79, v210
  v_dot2c_f32_bf16 v177, s79, v211
  v_dot2c_f32_bf16 v176, s79, v212
  v_dot2c_f32_bf16 v177, s79, v213
  v_dot2c_f32_bf16 v176, s79, v214
  v_dot2c_f32_bf16 v177, s79, v215
  v_dot2c_f32_bf16 v176, s79, v216
  v_dot2c_f32_bf16 v177, s79, v217
  v_dot2c_f32_bf16 v176, s79, v218
  v_dot2c_f32_bf16 v177, s79, v219
  v_dot2c_f32_bf16 v176, s79, v220
  v_dot2c_f32_bf16 v177, s79, v221
  v_dot2c_f32_bf16 v176, s79, v222
  v_dot2c_f32_bf16 v177, s79, v223
  v_dot2c_f32_bf16 v176, s79, v224
  v_dot2c_f32_bf16 v177, s79, v225
  v_dot2c_f32_bf16 v176, s79, v226
  v_dot2c_f32_bf16 v177, s79, v227
  v_dot2c_f32_bf16 v176, s79, v228
  v_dot2c_f32_bf16 v177, s79, v229
  s_nop 2
  v_add_f32 v176, v176, v177
  buffer_store_dword v176, v204, s[28:31], s72 offen sc1
L_nocs_4:
  s_waitcnt vmcnt(6)
  v_add_u32 v116, 131072, v112
  v_add_u32 v117, 131072, v113
  v_add_u32 v118, 131072, v114
  v_add_u32 v119, 131072, v115
  ds_read_b128 a[64:67], v116 offset:0
  ds_read_b128 a[68:71], v117 offset:0
  ds_read_b128 a[72:75], v118 offset:0
  ds_read_b128 a[76:79], v119 offset:0
  ds_read_b128 a[80:83], v116 offset:16384
  ds_read_b128 a[84:87], v117 offset:16384
  ds_read_b128 a[88:91], v118 offset:16384
  ds_read_b128 a[92:95], v119 offset:16384
  v_add_u32 v116, 65536, v112
  v_add_u32 v117, 65536, v113
  v_add_u32 v118, 65536, v114
  v_add_u32 v119, 65536, v115
  ds_read_b128 a[96:99], v116 offset:0
  ds_read_b128 a[100:103], v117 offset:0
  ds_read_b128 a[104:107], v118 offset:0
  ds_read_b128 a[108:111], v119 offset:0
  ds_read_b128 a[112:115], v116 offset:16384
  ds_read_b128 a[116:119], v117 offset:16384
  ds_read_b128 a[120:123], v118 offset:16384
  ds_read_b128 a[124:127], v119 offset:16384
  ds_read_b128 a[128:131], v116 offset:32768
  ds_read_b128 a[132:135], v117 offset:32768
  ds_read_b128 a[136:139], v118 offset:32768
  ds_read_b128 a[140:143], v119 offset:32768
  ds_read_b128 a[144:147], v116 offset:49152
  ds_read_b128 a[148:151], v117 offset:49152
  ds_read_b128 a[152:155], v118 offset:49152
  ds_read_b128 a[156:159], v119 offset:49152
  v_add_u32 v3, 0x10000, v2
  v_add_u32 v4, 0x20000, v2
  s_waitcnt lgkmcnt(0)
  s_waitcnt vmcnt(5)
  s_cmp_lg_u32 s48, 0
  s_cbranch_scc1 L_wt_5
  s_mov_b32 s57, 0
  s_mov_b64 exec, 0xffffffff
  v_cmp_ne_u32 vcc, s51, v7
  s_nop 0
  s_cbranch_vccz L_pd_7
L_poll_6:
  buffer_load_dword v7, v6, s[28:31], s58 offen sc1
  s_add_u32 s57, s57, 1
  s_waitcnt vmcnt(0)
  v_cmp_ne_u32 vcc, s51, v7
  s_cmp_ge_u32 s57, 32768
  s_cbranch_scc1 L_pd_7
  s_cbranch_vccnz L_poll_6
L_pd_7:
  s_mov_b64 exec, -1
L_wt_5:
  s_barrier
  s_mov_b32 m0, s7
  s_nop 0
  buffer_load_dwordx4 v2, s[28:31], s53 offen sc1 lds
  s_add_u32 m0, m0, 4096
  s_add_u32 s53, s53, 4096
  buffer_load_dwordx4 v2, s[28:31], s53 offen sc1 lds
  s_add_u32 m0, m0, 4096
  s_add_u32 s53, s53, 4096
  buffer_load_dwordx4 v2, s[28:31], s53 offen sc1 lds
  s_add_u32 m0, m0, 4096
  s_add_u32 s53, s53, 4096
  s_cmp_ge_u32 s53, s101
  s_cselect_b32 s55, 122880, 0
  s_sub_u32 s53, s53, s55
  buffer_load_dwordx2 v[122:123], v120, s[28:31], s17 offen sc1
  buffer_load_dwordx4 v[124:127], v2, s[28:31], s54 offen offset:0 sc1
  buffer_load_dwordx4 v[128:131], v2, s[28:31], s54 offen offset:1024 sc1
  buffer_load_dwordx4 v2, s[28:31], s53 offen sc1 lds
  s_add_u32 m0, m0, 4096
  s_add_u32 s53, s53, 4096
  buffer_load_dwordx4 v2, s[28:31], s53 offen sc1 lds
  s_add_u32 m0, m0, 4096
  s_add_u32 s53, s53, 4096
  buffer_load_dwordx4 v2, s[28:31], s53 offen sc1 lds
  s_add_u32 m0, m0, 4096
  s_add_u32 s53, s53, 4096
  s_cmp_ge_u32 s53, s101
  s_cselect_b32 s55, 122880, 0
  s_sub_u32 s53, s53, s55
  buffer_load_dwordx4 v2, s[28:31], s53 offen sc1 lds
  s_add_u32 m0, m0, 4096
  s_add_u32 s53, s53, 4096
  buffer_load_dwordx4 v2, s[28:31], s53 offen sc1 lds
  s_add_u32 m0, m0, 4096
  s_add_u32 s53, s53, 4096
  buffer_load_dwordx4 v2, s[28:31], s53 offen sc1 lds
  s_add_u32 m0, m0, 4096
  s_add_u32 s53, s53, 4096
  s_cmp_ge_u32 s53, s101
  s_cselect_b32 s55, 122880, 0
  s_sub_u32 s53, s53, s55
  buffer_load_dwordx4 v2, s[28:31], s53 offen sc1 lds
  s_add_u32 m0, m0, 4096
  s_add_u32 s53, s53, 4096
  buffer_load_dwordx4 v2, s[28:31], s53 offen sc1 lds
  s_add_u32 m0, m0, 4096
  s_add_u32 s53, s53, 4096
  buffer_load_dwordx4 v2, s[28:31], s53 offen sc1 lds
  s_add_u32 m0, m0, 4096
  s_add_u32 s53, s53, 4096
  s_cmp_ge_u32 s53, s101
  s_cselect_b32 s55, 122880, 0
  s_sub_u32 s53, s53, s55
  s_waitcnt vmcnt(12)
  s_barrier
  ds_read_b128 a[160:163], v2 offset:0
  ds_read_b128 a[164:167], v2 offset:1024
  ds_read_b128 a[168:171], v2 offset:2048
  ds_read_b128 a[172:175], v2 offset:3072
  ds_read_b128 a[176:179], v2 offset:4096
  ds_read_b128 a[180:183], v2 offset:5120
  ds_read_b128 a[184:187], v2 offset:6144
  ds_read_b128 a[188:191], v2 offset:7168
  ds_read_b128 a[192:195], v2 offset:8192
  s_waitcnt lgkmcnt(7)
  v_mfma_f32_32x32x16_bf16 v[32:47], a[160:163], a[0:3], 0
  ds_read_b128 a[196:199], v2 offset:9216
  buffer_load_dwordx4 v2, s[28:31], s53 offen sc1 lds
  s_add_u32 m0, m0, 4096
  v_mfma_f32_32x32x16_bf16 v[48:63], a[164:167], a[0:3], 0
  ds_read_b128 a[200:203], v2 offset:10240
  s_add_u32 s53, s53, 4096
  buffer_load_dwordx4 v2, s[28:31], s53 offen sc1 lds
  s_waitcnt lgkmcnt(7)
  v_mfma_f32_32x32x16_bf16 v[64:79], a[168:171], a[0:3], 0
  ds_read_b128 a[204:207], v2 offset:11264
  s_add_u32 m0, m0, 4096
  s_add_u32 s53, s53, 4096
  s_waitcnt vmcnt(8)
  s_barrier
  s_cmp_lg_u32 s48, 0
  s_cbranch_scc1 L_sig_10
  s_lshr_b32 s58, s2, 2
  s_lshl_b32 s58, s58, 7
  s_add_u32 s58, s58, 24342528
  s_and_b32 s59, s2, 3
  s_lshl_b32 s59, s59, 2
  v_mov_b32 v6, s59
  v_mov_b32 v7, s51
  s_mov_b64 exec, 1
  buffer_store_dword v7, v6, s[28:31], s58 offen sc1
  s_mov_b64 exec, -1
L_sig_10:
  v_mfma_f32_32x32x16_bf16 v[32:47], a[172:175], a[4:7], v[32:47]
  ds_read_b128 a[208:211], v2 offset:12288
  buffer_load_dwordx4 v2, s[28:31], s53 offen sc1 lds
  s_add_u32 m0, m0, 4096
  s_waitcnt lgkmcnt(7)
  v_mfma_f32_32x32x16_bf16 v[48:63], a[176:179], a[4:7], v[48:63]
  ds_read_b128 a[212:215], v2 offset:13312
  s_add_u32 s53, s53, 4096
  s_cmp_ge_u32 s53, s101
  s_cselect_b32 s55, 122880, 0
  s_sub_u32 s53, s53, s55
  v_mfma_f32_32x32x16_bf16 v[64:79], a[180:183], a[4:7], v[64:79]
  ds_read_b128 a[216:219], v2 offset:14336
  buffer_load_dwordx4 v2, s[28:31], s53 offen sc1 lds
  s_add_u32 m0, m0, 4096
  s_waitcnt lgkmcnt(7)
  v_mfma_f32_32x32x16_bf16 v[32:47], a[184:187], a[8:11], v[32:47]
  ds_read_b128 a[220:223], v2 offset:15360
  s_add_u32 s53, s53, 4096
  buffer_load_dwordx4 v2, s[28:31], s53 offen sc1 lds
  v_mfma_f32_32x32x16_bf16 v[48:63], a[188:191], a[8:11], v[48:63]
  ds_read_b128 a[224:227], v2 offset:16384
  s_add_u32 m0, m0, 4096
  s_add_u32 s53, s53, 4096
  s_waitcnt lgkmcnt(7)
  v_mfma_f32_32x32x16_bf16 v[64:79], a[192:195], a[8:11], v[64:79]
  ds_read_b128 a[228:231], v2 offset:17408
  buffer_load_dwordx4 v2, s[28:31], s53 offen sc1 lds
  v_mfma_f32_32x32x16_bf16 v[32:47], a[196:199], a[12:15], v[32:47]
  ds_read_b128 a[232:235], v2 offset:18432
  s_add_u32 m0, m0, 4096
  s_waitcnt lgkmcnt(7)
  v_mfma_f32_32x32x16_bf16 v[48:63], a[200:203], a[12:15], v[48:63]
  ds_read_b128 a[236:239], v2 offset:19456
  s_add_u32 s53, s53, 4096
  v_mfma_f32_32x32x16_bf16 v[64:79], a[204:207], a[12:15], v[64:79]
  ds_read_b128 a[240:243], v2 offset:20480
  s_cmp_ge_u32 s53, s101
  s_cselect_b32 s55, 122880, 0
  s_sub_u32 s53, s53, s55
  s_waitcnt vmcnt(15)
  s_waitcnt lgkmcnt(7)
  v_mfma_f32_32x32x16_bf16 v[32:47], a[208:211], a[16:19], v[32:47]
  ds_read_b128 a[244:247], v2 offset:21504
  buffer_load_dwordx4 v2, s[28:31], s53 offen sc1 lds
  s_add_u32 m0, m0, 4096
  v_add_f32 v124, v124, v128
  v_add_f32 v125, v125, v129
  v_mfma_f32_32x32x16_bf16 v[48:63], a[212:215], a[16:19], v[48:63]
  ds_read_b128 a[248:251], v2 offset:22528
  s_add_u32 s53, s53, 4096
  buffer_load_dwordx4 v2, s[28:31], s53 offen sc1 lds
  v_add_f32 v126, v126, v130
  v_add_f32 v127, v127, v131
  s_waitcnt lgkmcnt(7)
  v_mfma_f32_32x32x16_bf16 v[64:79], a[216:219], a[16:19], v[64:79]
  ds_read_b128 a[252:255], v2 offset:23552
  s_add_u32 m0, m0, 4096
  s_add_u32 s53, s53, 4096
  v_mov_b32 v128, v124
  v_mov_b32 v129, v125
  s_waitcnt vmcnt(11)
  s_barrier
  v_mfma_f32_32x32x16_bf16 v[32:47], a[220:223], a[20:23], v[32:47]
  ds_read_b128 a[160:163], v2 offset:24576
  buffer_load_dwordx4 v2, s[28:31], s53 offen sc1 lds
  s_add_u32 m0, m0, 4096
  v_mov_b32 v130, v126
  v_mov_b32 v131, v127
  s_waitcnt lgkmcnt(7)
  v_mfma_f32_32x32x16_bf16 v[48:63], a[224:227], a[20:23], v[48:63]
  ds_read_b128 a[164:167], v2 offset:25600
  s_add_u32 s53, s53, 4096
  s_cmp_ge_u32 s53, s101
  s_cselect_b32 s55, 122880, 0
  s_sub_u32 s53, s53, s55
  v_permlane32_swap_b32 v124, v128
  v_permlane32_swap_b32 v125, v129
  v_mfma_f32_32x32x16_bf16 v[64:79], a[228:231], a[20:23], v[64:79]
  ds_read_b128 a[168:171], v2 offset:26624
  buffer_load_dwordx4 v2, s[28:31], s53 offen sc1 lds
  s_add_u32 m0, m0, 4096
  v_permlane32_swap_b32 v126, v130
  v_permlane32_swap_b32 v127, v131
  s_waitcnt lgkmcnt(7)
  v_mfma_f32_32x32x16_bf16 v[32:47], a[232:235], a[24:27], v[32:47]
  ds_read_b128 a[172:175], v2 offset:27648
  s_add_u32 s53, s53, 4096
  buffer_load_dwordx4 v2, s[28:31], s53 offen sc1 lds
  v_add_f32 v124, v124, v128
  v_add_f32 v125, v125, v129
  v_mfma_f32_32x32x16_bf16 v[48:63], a[236:239], a[24:27], v[48:63]
  ds_read_b128 a[176:179], v2 offset:28672
  s_add_u32 m0, m0, 4096
  s_add_u32 s53, s53, 4096
  v_add_f32 v126, v126, v130
  v_add_f32 v127, v127, v131
  s_waitcnt lgkmcnt(7)
  v_mfma_f32_32x32x16_bf16 v[64:79], a[240:243], a[24:27], v[64:79]
  ds_read_b128 a[180:183], v2 offset:29696
  buffer_load_dwordx4 v2, s[28:31], s53 offen sc1 lds
  ds_write_b128 v235, v[124:127]
  v_mov_b32 v230, v123
  v_mfma_f32_32x32x16_bf16 v[32:47], a[244:247], a[28:31], v[32:47]
  ds_read_b128 a[184:187], v2 offset:30720
  s_add_u32 m0, m0, 4096
  v_mul_f32 v232, s84, v123
  v_cmp_gt_u32 vcc, 32, v1
  s_waitcnt lgkmcnt(7)
  v_mfma_f32_32x32x16_bf16 v[48:63], a[248:251], a[28:31], v[48:63]
  ds_read_b128 a[188:191], v2 offset:31744
  s_add_u32 s53, s53, 4096
  v_cndmask_b32 v122, 0, v122, vcc
  v_cvt_pk_bf16_f32 v236, v122, v122
  v_mfma_f32_32x32x16_bf16 v[64:79], a[252:255], a[28:31], v[64:79]
  ds_read_b128 a[192:195], v2 offset:32768
  s_cmp_ge_u32 s53, s101
  s_cselect_b32 s55, 122880, 0
  s_sub_u32 s53, s53, s55
  v_lshlrev_b32 v123, 16, v236
  v_sub_f32 v123, v122, v123
  s_waitcnt lgkmcnt(7)
  v_mfma_f32_32x32x16_bf16 v[32:47], a[160:163], a[32:35], v[32:47]
  ds_read_b128 a[196:199], v2 offset:33792
  buffer_load_dwordx4 v2, s[28:31], s53 offen sc1 lds
  s_add_u32 m0, m0, 4096
  v_cvt_pk_bf16_f32 v237, v123, 0
  v_mfma_f32_32x32x16_bf16 v[48:63], a[164:167], a[32:35], v[48:63]
  ds_read_b128 a[200:203], v2 offset:34816
  s_add_u32 s53, s53, 4096
  buffer_load_dwordx4 v2, s[28:31], s53 offen sc1 lds
  v_mov_b32 v238, 0
  s_waitcnt lgkmcnt(7)
  v_mfma_f32_32x32x16_bf16 v[64:79], a[168:171], a[32:35], v[64:79]
  ds_read_b128 a[204:207], v2 offset:35840
  s_add_u32 m0, m0, 4096
  s_add_u32 s53, s53, 4096
  v_mov_b32 v239, 0
  s_waitcnt vmcnt(14)
  s_barrier
  v_mfma_f32_32x32x16_bf16 v[32:47], a[172:175], a[36:39], v[32:47]
  ds_read_b128 a[208:211], v2 offset:36864
  buffer_load_dwordx4 v2, s[28:31], s53 offen sc1 lds
  s_add_u32 m0, m0, 4096
  s_waitcnt lgkmcnt(7)
  v_mfma_f32_32x32x16_bf16 v[48:63], a[176:179], a[36:39], v[48:63]
  ds_read_b128 a[212:215], v2 offset:37888
  s_add_u32 s53, s53, 4096
  s_cmp_ge_u32 s53, s101
  s_cselect_b32 s55, 122880, 0
  s_sub_u32 s53, s53, s55
  v_mfma_f32_32x32x16_bf16 v[64:79], a[180:183], a[36:39], v[64:79]
  ds_read_b128 a[216:219], v2 offset:38912
  buffer_load_dwordx4 v2, s[28:31], s53 offen sc1 lds
  s_add_u32 m0, m0, 4096
  s_waitcnt lgkmcnt(7)
  v_mfma_f32_32x32x16_bf16 v[32:47], a[184:187], a[40:43], v[32:47]
  ds_read_b128 a[220:223], v2 offset:39936
  s_add_u32 s53, s53, 4096
  buffer_load_dwordx4 v2, s[28:31], s53 offen sc1 lds
  v_mfma_f32_32x32x16_bf16 v[48:63], a[188:191], a[40:43], v[48:63]
  ds_read_b128 a[224:227], v2 offset:40960
  s_add_u32 m0, m0, 4096
  s_add_u32 s53, s53, 4096
  s_waitcnt lgkmcnt(7)
  v_mfma_f32_32x32x16_bf16 v[64:79], a[192:195], a[40:43], v[64:79]
  ds_read_b128 a[228:231], v2 offset:41984
  buffer_load_dwordx4 v2, s[28:31], s53 offen sc1 lds
  v_mfma_f32_32x32x16_bf16 v[32:47], a[196:199], a[44:47], v[32:47]
  ds_read_b128 a[232:235], v2 offset:43008
  s_add_u32 m0, m0, 4096
  s_waitcnt lgkmcnt(7)
  v_mfma_f32_32x32x16_bf16 v[48:63], a[200:203], a[44:47], v[48:63]
  ds_read_b128 a[236:239], v2 offset:44032
  s_add_u32 s53, s53, 4096
  v_mfma_f32_32x32x16_bf16 v[64:79], a[204:207], a[44:47], v[64:79]
  ds_read_b128 a[240:243], v2 offset:45056
  s_cmp_ge_u32 s53, s101
  s_cselect_b32 s55, 122880, 0
  s_sub_u32 s53, s53, s55
  s_waitcnt lgkmcnt(7)
  v_mfma_f32_32x32x16_bf16 v[32:47], a[208:211], a[48:51], v[32:47]
  ds_read_b128 a[244:247], v2 offset:46080
  v_mfma_f32_32x32x16_bf16 v[48:63], a[212:215], a[48:51], v[48:63]
  ds_read_b128 a[248:251], v2 offset:47104
  s_waitcnt lgkmcnt(7)
  v_mfma_f32_32x32x16_bf16 v[64:79], a[216:219], a[48:51], v[64:79]
  ds_read_b128 a[252:255], v2 offset:48128
  s_waitcnt vmcnt(15)
  s_barrier
  v_mfma_f32_32x32x16_bf16 v[32:47], a[220:223], a[52:55], v[32:47]
  ds_read_b128 a[160:163], v2 offset:49152
  s_waitcnt lgkmcnt(7)
  v_mfma_f32_32x32x16_bf16 v[48:63], a[224:227], a[52:55], v[48:63]
  ds_read_b128 a[164:167], v2 offset:50176
  v_mfma_f32_32x32x16_bf16 v[64:79], a[228:231], a[52:55], v[64:79]
  ds_read_b128 a[168:171], v2 offset:51200
  s_waitcnt lgkmcnt(7)
  v_mfma_f32_32x32x16_bf16 v[32:47], a[232:235], a[56:59], v[32:47]
  ds_read_b128 a[172:175], v2 offset:52224
  v_mfma_f32_32x32x16_bf16 v[48:63], a[236:239], a[56:59], v[48:63]
  ds_read_b128 a[176:179], v2 offset:53248
  s_waitcnt lgkmcnt(7)
  v_mfma_f32_32x32x16_bf16 v[64:79], a[240:243], a[56:59], v[64:79]
  ds_read_b128 a[180:183], v2 offset:54272
  v_mfma_f32_32x32x16_bf16 v[32:47], a[244:247], a[60:63], v[32:47]
  ds_read_b128 a[184:187], v2 offset:55296
  s_waitcnt lgkmcnt(7)
  v_mfma_f32_32x32x16_bf16 v[48:63], a[248:251], a[60:63], v[48:63]
  ds_read_b128 a[188:191], v2 offset:56320
  v_mfma_f32_32x32x16_bf16 v[64:79], a[252:255], a[60:63], v[64:79]
  ds_read_b128 a[192:195], v2 offset:57344
  s_waitcnt lgkmcnt(7)
  v_mfma_f32_32x32x16_bf16 v[32:47], a[160:163], a[64:67], v[32:47]
  ds_read_b128 a[196:199], v2 offset:58368
  ds_read_b32 v124, v240 offset:0
  ds_read_b32 v125, v240 offset:128
  v_mfma_f32_32x32x16_bf16 v[48:63], a[164:167], a[64:67], v[48:63]
  ds_read_b128 a[200:203], v2 offset:59392
  ds_read_b32 v126, v240 offset:256
  ds_read_b32 v127, v240 offset:384
  s_waitcnt lgkmcnt(7)
  v_mfma_f32_32x32x16_bf16 v[64:79], a[168:171], a[64:67], v[64:79]
  ds_read_b128 a[204:207], v2 offset:60416
  ds_read_b32 v128, v240 offset:512
  ds_read_b32 v129, v240 offset:640
  s_waitcnt vmcnt(12)
  s_barrier
  v_mfma_f32_32x32x16_bf16 v[32:47], a[172:175], a[68:71], v[32:47]
  ds_read_b128 a[208:211], v2 offset:61440
  ds_read_b32 v130, v240 offset:768
  ds_read_b32 v131, v240 offset:896
  s_waitcnt lgkmcnt(7)
  v_mfma_f32_32x32x16_bf16 v[48:63], a[176:179], a[68:71], v[48:63]
  ds_read_b128 a[212:215], v2 offset:62464
  ds_read_b32 v132, v240 offset:1024
  v_mfma_f32_32x32x16_bf16 v[64:79], a[180:183], a[68:71], v[64:79]
  ds_read_b128 a[216:219], v2 offset:63488
  ds_read_b32 v133, v240 offset:1152
  s_waitcnt lgkmcnt(7)
  v_mfma_f32_32x32x16_bf16 v[32:47], a[184:187], a[72:75], v[32:47]
  ds_read_b128 a[220:223], v2 offset:64512
  ds_read_b32 v134, v240 offset:1280
  v_mfma_f32_32x32x16_bf16 v[48:63], a[188:191], a[72:75], v[48:63]
  ds_read_b128 a[224:227], v3 offset:0
  ds_read_b32 v135, v240 offset:1408
  s_waitcnt lgkmcnt(7)
  v_mfma_f32_32x32x16_bf16 v[64:79], a[192:195], a[72:75], v[64:79]
  ds_read_b128 a[228:231], v3 offset:1024
  ds_read_b32 v136, v240 offset:1536
  v_mfma_f32_32x32x16_bf16 v[32:47], a[196:199], a[76:79], v[32:47]
  ds_read_b128 a[232:235], v3 offset:2048
  ds_read_b32 v137, v240 offset:1664
  s_waitcnt lgkmcnt(7)
  v_mfma_f32_32x32x16_bf16 v[48:63], a[200:203], a[76:79], v[48:63]
  ds_read_b128 a[236:239], v3 offset:3072
  ds_read_b32 v138, v240 offset:1792
  v_mfma_f32_32x32x16_bf16 v[64:79], a[204:207], a[76:79], v[64:79]
  ds_read_b128 a[240:243], v3 offset:4096
  ds_read_b32 v139, v240 offset:1920
  s_waitcnt lgkmcnt(7)
  v_mfma_f32_32x32x16_bf16 v[32:47], a[208:211], a[80:83], v[32:47]
  ds_read_b128 a[244:247], v3 offset:5120
  v_mfma_f32_32x32x16_bf16 v[48:63], a[212:215], a[80:83], v[48:63]
  ds_read_b128 a[248:251], v3 offset:6144
  s_waitcnt lgkmcnt(7)
  v_mfma_f32_32x32x16_bf16 v[64:79], a[216:219], a[80:83], v[64:79]
  ds_read_b128 a[252:255], v3 offset:7168
  s_waitcnt vmcnt(9)
  s_barrier
  v_mfma_f32_32x32x16_bf16 v[32:47], a[220:223], a[84:87], v[32:47]
  ds_read_b128 a[160:163], v3 offset:8192
  s_waitcnt lgkmcnt(7)
  v_mfma_f32_32x32x16_bf16 v[48:63], a[224:227], a[84:87], v[48:63]
  ds_read_b128 a[164:167], v3 offset:9216
  v_mfma_f32_32x32x16_bf16 v[64:79], a[228:231], a[84:87], v[64:79]
  ds_read_b128 a[168:171], v3 offset:10240
  s_waitcnt lgkmcnt(7)
  v_mfma_f32_32x32x16_bf16 v[32:47], a[232:235], a[88:91], v[32:47]
  ds_read_b128 a[172:175], v3 offset:11264
  v_mfma_f32_32x32x16_bf16 v[48:63], a[236:239], a[88:91], v[48:63]
  ds_read_b128 a[176:179], v3 offset:12288
  s_waitcnt lgkmcnt(7)
  v_mfma_f32_32x32x16_bf16 v[64:79], a[240:243], a[88:91], v[64:79]
  ds_read_b128 a[180:183], v3 offset:13312
  v_mfma_f32_32x32x16_bf16 v[32:47], a[244:247], a[92:95], v[32:47]
  ds_read_b128 a[184:187], v3 offset:14336
  s_waitcnt lgkmcnt(7)
  v_mfma_f32_32x32x16_bf16 v[48:63], a[248:251], a[92:95], v[48:63]
  ds_read_b128 a[188:191], v3 offset:15360
  v_mfma_f32_32x32x16_bf16 v[64:79], a[252:255], a[92:95], v[64:79]
  ds_read_b128 a[192:195], v3 offset:16384
  s_waitcnt lgkmcnt(7)
  v_mfma_f32_32x32x16_bf16 v[32:47], a[160:163], a[96:99], v[32:47]
  ds_read_b128 a[196:199], v3 offset:17408
  v_add_f32 v124, v124, v128
  v_add_f32 v125, v125, v129
  v_mfma_f32_32x32x16_bf16 v[48:63], a[164:167], a[96:99], v[48:63]
  ds_read_b128 a[200:203], v3 offset:18432
  v_add_f32 v126, v126, v130
  v_add_f32 v127, v127, v131
  s_waitcnt lgkmcnt(7)
  v_mfma_f32_32x32x16_bf16 v[64:79], a[168:171], a[96:99], v[64:79]
  ds_read_b128 a[204:207], v3 offset:19456
  v_add_f32 v124, v124, v132
  v_add_f32 v125, v125, v133
  s_waitcnt vmcnt(6)
  s_barrier
  v_mfma_f32_32x32x16_bf16 v[32:47], a[172:175], a[100:103], v[32:47]
  ds_read_b128 a[208:211], v3 offset:20480
  v_add_f32 v126, v126, v134
  v_add_f32 v127, v127, v135
  s_waitcnt lgkmcnt(7)
  v_mfma_f32_32x32x16_bf16 v[48:63], a[176:179], a[100:103], v[48:63]
  ds_read_b128 a[212:215], v3 offset:21504
  v_add_f32 v124, v124, v136
  v_add_f32 v125, v125, v137
  v_mfma_f32_32x32x16_bf16 v[64:79], a[180:183], a[100:103], v[64:79]
  ds_read_b128 a[216:219], v3 offset:22528
  v_add_f32 v126, v126, v138
  v_add_f32 v127, v127, v139
  s_waitcnt lgkmcnt(7)
  v_mfma_f32_32x32x16_bf16 v[32:47], a[184:187], a[104:107], v[32:47]
  ds_read_b128 a[220:223], v3 offset:23552
  v_cvt_pk_bf16_f32 v97, v124, 0
  v_lshlrev_b32 v128, 16, v97
  v_mfma_f32_32x32x16_bf16 v[48:63], a[188:191], a[104:107], v[48:63]
  ds_read_b128 a[224:227], v3 offset:24576
  v_sub_f32 v128, v124, v128
  v_cvt_pk_bf16_f32 v96, v124, v128
  s_waitcnt lgkmcnt(7)
  v_mfma_f32_32x32x16_bf16 v[64:79], a[192:195], a[104:107], v[64:79]
  ds_read_b128 a[228:231], v3 offset:25600
  v_mov_b32 v98, 0
  v_mov_b32 v99, 0
  v_mfma_f32_32x32x16_bf16 v[32:47], a[196:199], a[108:111], v[32:47]
  ds_read_b128 a[232:235], v3 offset:26624
  v_cvt_pk_bf16_f32 v101, v125, 0
  v_lshlrev_b32 v129, 16, v101
  s_waitcnt lgkmcnt(7)
  v_mfma_f32_32x32x16_bf16 v[48:63], a[200:203], a[108:111], v[48:63]
  ds_read_b128 a[236:239], v3 offset:27648
  v_sub_f32 v129, v125, v129
  v_cvt_pk_bf16_f32 v100, v125, v129
  v_mfma_f32_32x32x16_bf16 v[64:79], a[204:207], a[108:111], v[64:79]
  ds_read_b128 a[240:243], v3 offset:28672
  v_mov_b32 v102, 0
  v_mov_b32 v103, 0
  s_waitcnt lgkmcnt(7)
  v_mfma_f32_32x32x16_bf16 v[32:47], a[208:211], a[112:115], v[32:47]
  ds_read_b128 a[244:247], v3 offset:29696
  buffer_load_dwordx4 v2, s[28:31], s100 offen sc1 lds
  s_add_u32 m0, m0, 4096
  s_add_u32 s100, s100, 4096
  v_cvt_pk_bf16_f32 v105, v126, 0
  v_mfma_f32_32x32x16_bf16 v[48:63], a[212:215], a[112:115], v[48:63]
  ds_read_b128 a[248:251], v3 offset:30720
  s_add_u32 s55, s101, 40960
  s_cmp_ge_u32 s100, s55
  s_cselect_b32 s55, 40960, 0
  s_sub_u32 s100, s100, s55
  buffer_load_dwordx4 v2, s[28:31], s100 offen sc1 lds
  v_lshlrev_b32 v130, 16, v105
  s_waitcnt lgkmcnt(7)
  v_mfma_f32_32x32x16_bf16 v[64:79], a[216:219], a[112:115], v[64:79]
  ds_read_b128 a[252:255], v3 offset:31744
  s_add_u32 m0, m0, 4096
  s_add_u32 s100, s100, 4096
  s_add_u32 s55, s101, 40960
  v_sub_f32 v130, v126, v130
  s_waitcnt vmcnt(5)
  s_barrier
  v_mfma_f32_32x32x16_bf16 v[32:47], a[220:223], a[116:119], v[32:47]
  ds_read_b128 a[160:163], v3 offset:32768
  s_cmp_ge_u32 s100, s55
  s_cselect_b32 s55, 40960, 0
  s_sub_u32 s100, s100, s55
  buffer_load_dwordx4 v2, s[28:31], s100 offen sc1 lds
  s_add_u32 m0, m0, 4096
  v_cvt_pk_bf16_f32 v104, v126, v130
  s_waitcnt lgkmcnt(7)
  v_mfma_f32_32x32x16_bf16 v[48:63], a[224:227], a[116:119], v[48:63]
  ds_read_b128 a[164:167], v3 offset:33792
  s_add_u32 s100, s100, 4096
  s_add_u32 s55, s101, 40960
  s_cmp_ge_u32 s100, s55
  s_cselect_b32 s55, 40960, 0
  s_sub_u32 s100, s100, s55
  v_mov_b32 v106, 0
  v_mfma_f32_32x32x16_bf16 v[64:79], a[228:231], a[116:119], v[64:79]
  ds_read_b128 a[168:171], v3 offset:34816
  buffer_load_dwordx4 v2, s[28:31], s100 offen sc1 lds
  s_add_u32 m0, m0, 4096
  s_add_u32 s100, s100, 4096
  v_mov_b32 v107, 0
  s_waitcnt lgkmcnt(7)
  v_mfma_f32_32x32x16_bf16 v[32:47], a[232:235], a[120:123], v[32:47]
  ds_read_b128 a[172:175], v3 offset:35840
  s_add_u32 s55, s101, 40960
  s_cmp_ge_u32 s100, s55
  s_cselect_b32 s55, 40960, 0
  s_sub_u32 s100, s100, s55
  v_cvt_pk_bf16_f32 v109, v127, 0
  v_mfma_f32_32x32x16_bf16 v[48:63], a[236:239], a[120:123], v[48:63]
  ds_read_b128 a[176:179], v3 offset:36864
  buffer_load_dwordx4 v2, s[28:31], s100 offen sc1 lds
  s_add_u32 m0, m0, 4096
  v_lshlrev_b32 v131, 16, v109
  s_waitcnt lgkmcnt(7)
  v_mfma_f32_32x32x16_bf16 v[64:79], a[240:243], a[120:123], v[64:79]
  ds_read_b128 a[180:183], v3 offset:37888
  s_add_u32 s100, s100, 4096
  s_add_u32 s55, s101, 40960
  v_sub_f32 v131, v127, v131
  v_mfma_f32_32x32x16_bf16 v[32:47], a[244:247], a[124:127], v[32:47]
  ds_read_b128 a[184:187], v3 offset:38912
  s_cmp_ge_u32 s100, s55
  s_cselect_b32 s55, 40960, 0
  s_sub_u32 s100, s100, s55
  buffer_load_dwordx4 v2, s[28:31], s100 offen sc1 lds
  v_cvt_pk_bf16_f32 v108, v127, v131
  s_waitcnt lgkmcnt(7)
  v_mfma_f32_32x32x16_bf16 v[48:63], a[248:251], a[124:127], v[48:63]
  ds_read_b128 a[188:191], v3 offset:39936
  s_add_u32 m0, m0, 4096
  s_add_u32 s100, s100, 4096
  v_mov_b32 v110, 0
  v_mfma_f32_32x32x16_bf16 v[64:79], a[252:255], a[124:127], v[64:79]
  ds_read_b128 a[192:195], v3 offset:40960
  s_add_u32 s55, s101, 40960
  s_cmp_ge_u32 s100, s55
  s_cselect_b32 s55, 40960, 0
  s_sub_u32 s100, s100, s55
  v_mov_b32 v111, 0
  s_waitcnt lgkmcnt(7)
  v_mfma_f32_32x32x16_bf16 v[32:47], a[160:163], a[128:131], v[32:47]
  ds_read_b128 a[196:199], v3 offset:41984
  v_lshlrev_b32 v6, 7, v1
  s_mov_b32 s58, 24342528
  v_mfma_f32_32x32x16_bf16 v[48:63], a[164:167], a[128:131], v[48:63]
  ds_read_b128 a[200:203], v3 offset:43008
  buffer_load_dwordx4 v[196:199], v6, s[28:31], s58 offen sc1
  buffer_load_dwordx4 v2, s[28:31], s100 offen sc1 lds
  s_waitcnt lgkmcnt(7)
  v_mfma_f32_32x32x16_bf16 v[64:79], a[168:171], a[128:131], v[64:79]
  ds_read_b128 a[204:207], v3 offset:44032
  s_add_u32 m0, m0, 4096
  s_add_u32 s100, s100, 4096
  s_waitcnt vmcnt(8)
  s_barrier
  v_mfma_f32_32x32x16_bf16 v[32:47], a[172:175], a[132:135], v[32:47]
  ds_read_b128 a[208:211], v3 offset:45056
  s_add_u32 s55, s101, 40960
  s_cmp_ge_u32 s100, s55
  s_cselect_b32 s55, 40960, 0
  s_sub_u32 s100, s100, s55
  s_waitcnt lgkmcnt(7)
  v_mfma_f32_32x32x16_bf16 v[48:63], a[176:179], a[132:135], v[48:63]
  ds_read_b128 a[212:215], v3 offset:46080
  buffer_load_dwordx4 v2, s[28:31], s100 offen sc1 lds
  s_add_u32 m0, m0, 4096
  v_mfma_f32_32x32x16_bf16 v[64:79], a[180:183], a[132:135], v[64:79]
  ds_read_b128 a[216:219], v3 offset:47104
  s_add_u32 s100, s100, 4096
  s_add_u32 s55, s101, 40960
  s_waitcnt lgkmcnt(7)
  v_mfma_f32_32x32x16_bf16 v[32:47], a[184:187], a[136:139], v[32:47]
  ds_read_b128 a[220:223], v3 offset:48128
  s_cmp_ge_u32 s100, s55
  s_cselect_b32 s55, 40960, 0
  s_sub_u32 s100, s100, s55
  buffer_load_dwordx4 v2, s[28:31], s100 offen sc1 lds
  v_mfma_f32_32x32x16_bf16 v[48:63], a[188:191], a[136:139], v[48:63]
  ds_read_b128 a[224:227], v3 offset:49152
  s_add_u32 m0, m0, 4096
  s_add_u32 s100, s100, 4096
  s_waitcnt lgkmcnt(7)
  v_mfma_f32_32x32x16_bf16 v[64:79], a[192:195], a[136:139], v[64:79]
  ds_read_b128 a[228:231], v3 offset:50176
  s_add_u32 s55, s101, 40960
  s_cmp_ge_u32 s100, s55
  s_cselect_b32 s55, 40960, 0
  s_sub_u32 s100, s100, s55
  v_mfma_f32_32x32x16_bf16 v[32:47], a[196:199], a[140:143], v[32:47]
  ds_read_b128 a[232:235], v3 offset:51200
  buffer_load_dwordx4 v2, s[28:31], s100 offen sc1 lds
  s_add_u32 m0, m0, 4096
  s_waitcnt lgkmcnt(7)
  v_mfma_f32_32x32x16_bf16 v[48:63], a[200:203], a[140:143], v[48:63]
  ds_read_b128 a[236:239], v3 offset:52224
  s_add_u32 s100, s100, 4096
  s_add_u32 s55, s101, 40960
  v_mfma_f32_32x32x16_bf16 v[64:79], a[204:207], a[140:143], v[64:79]
  ds_read_b128 a[240:243], v3 offset:53248
  s_cmp_ge_u32 s100, s55
  s_cselect_b32 s55, 40960, 0
  s_sub_u32 s100, s100, s55
  s_waitcnt lgkmcnt(7)
  v_mfma_f32_32x32x16_bf16 v[32:47], a[208:211], a[144:147], v[32:47]
  ds_read_b128 a[244:247], v3 offset:54272
  v_mfma_f32_32x32x16_bf16 v[48:63], a[212:215], a[144:147], v[48:63]
  ds_read_b128 a[248:251], v3 offset:55296
  s_waitcnt lgkmcnt(7)
  v_mfma_f32_32x32x16_bf16 v[64:79], a[216:219], a[144:147], v[64:79]
  ds_read_b128 a[252:255], v3 offset:56320
  v_mfma_f32_32x32x16_bf16 v[32:47], a[220:223], a[148:151], v[32:47]
  s_waitcnt lgkmcnt(6)
  v_mfma_f32_32x32x16_bf16 v[48:63], a[224:227], a[148:151], v[48:63]
  v_mfma_f32_32x32x16_bf16 v[64:79], a[228:231], a[148:151], v[64:79]
  s_waitcnt lgkmcnt(4)
  v_mfma_f32_32x32x16_bf16 v[32:47], a[232:235], a[152:155], v[32:47]
  s_waitcnt vmcnt(4) lgkmcnt(0)
  s_cmp_lg_u32 s48, 0
  s_cbranch_scc1 L_chk_8
  v_xor_b32 v196, s51, v196
  v_xor_b32 v197, s51, v197
  v_xor_b32 v198, s51, v198
  v_xor_b32 v199, s51, v199
  v_or3_b32 v196, v196, v197, v198
  v_or_b32 v196, v196, v199
  v_cmp_ne_u32 vcc, 0, v196
  s_nop 0
  s_cbranch_vccz L_chk_8
  v_lshlrev_b32 v6, 7, v1
  s_mov_b32 s58, 24342528
  s_mov_b32 s57, 0
L_poll_11:
  buffer_load_dwordx4 v[196:199], v6, s[28:31], s58 offen sc1
  s_add_u32 s57, s57, 1
  s_waitcnt vmcnt(0)
  v_xor_b32 v196, s51, v196
  v_xor_b32 v197, s51, v197
  v_xor_b32 v198, s51, v198
  v_xor_b32 v199, s51, v199
  v_or3_b32 v196, v196, v197, v198
  v_or_b32 v196, v196, v199
  v_cmp_ne_u32 vcc, 0, v196
  s_cmp_ge_u32 s57, 32768
  s_cbranch_scc1 L_pd_12
  s_cbranch_vccnz L_poll_11
L_pd_12:
L_chk_8:
  s_barrier
  v_mfma_f32_32x32x16_bf16 v[48:63], a[236:239], a[152:155], v[48:63]
  s_waitcnt lgkmcnt(2)
  v_mfma_f32_32x32x16_bf16 v[64:79], a[240:243], a[152:155], v[64:79]
  v_mfma_f32_32x32x16_bf16 v[32:47], a[244:247], a[156:159], v[32:47]
  s_waitcnt lgkmcnt(0)
  v_mfma_f32_32x32x16_bf16 v[48:63], a[248:251], a[156:159], v[48:63]
  v_mfma_f32_32x32x16_bf16 v[64:79], a[252:255], a[156:159], v[64:79]
  v_mfma_f32_32x32x16_bf16 v[32:47], v[96:99], v[236:239], v[32:47]
  v_mfma_f32_32x32x16_bf16 v[48:63], v[100:103], v[236:239], v[48:63]
  v_mfma_f32_32x32x16_bf16 v[64:79], v[104:107], v[236:239], v[64:79]
  v_mov_b32 v122, 0
  v_mov_b32 v123, 0
  v_mov_b32 v166, 0x3f80
  v_mov_b32 v167, 0
  v_xor_b32 v97, 16, v246
  s_add_u32 s98, s92, 0
  buffer_load_dwordx4 a[160:163], v2, s[28:31], s98 offen offset:0 sc1
  v_xor_b32 v98, 32, v246
  v_xor_b32 v99, 48, v246
  v_xor_b32 v100, 64, v246
  v_xor_b32 v101, 80, v246
  v_xor_b32 v102, 96, v246
  v_xor_b32 v103, 112, v246
  v_cvt_pk_bf16_f32 v112, v32, v33
  v_cvt_pk_bf16_f32 v113, v34, v35
  v_cvt_pk_bf16_f32 v114, v36, v37
  v_cvt_pk_bf16_f32 v115, v38, v39
  v_cvt_pk_bf16_f32 v116, v40, v41
  buffer_load_dwordx4 a[164:167], v2, s[28:31], s98 offen offset:1024 sc1
  v_cvt_pk_bf16_f32 v117, v42, v43
  v_cvt_pk_bf16_f32 v118, v44, v45
  v_cvt_pk_bf16_f32 v119, v46, v47
  v_pk_mul_f32 v[48:49], v[48:49], v[230:231] op_sel_hi:[1,0]
  v_pk_mul_f32 v[50:51], v[50:51], v[230:231] op_sel_hi:[1,0]
  v_pk_mul_f32 v[52:53], v[52:53], v[230:231] op_sel_hi:[1,0]
  v_pk_mul_f32 v[54:55], v[54:55], v[230:231] op_sel_hi:[1,0]
  v_pk_mul_f32 v[56:57], v[56:57], v[230:231] op_sel_hi:[1,0]
  v_pk_mul_f32 v[58:59], v[58:59], v[230:231] op_sel_hi:[1,0]
  v_pk_mul_f32 v[60:61], v[60:61], v[230:231] op_sel_hi:[1,0]
  v_pk_mul_f32 v[62:63], v[62:63], v[230:231] op_sel_hi:[1,0]
  v_cvt_pk_bf16_f32 v156, v48, v49
  buffer_load_dwordx4 a[168:171], v2, s[28:31], s98 offen offset:2048 sc1
  v_cvt_pk_bf16_f32 v157, v50, v51
  v_cvt_pk_bf16_f32 v158, v52, v53
  v_cvt_pk_bf16_f32 v159, v54, v55
  v_cvt_pk_bf16_f32 v160, v56, v57
  v_cvt_pk_bf16_f32 v161, v58, v59
  v_cvt_pk_bf16_f32 v162, v60, v61
  v_cvt_pk_bf16_f32 v163, v62, v63
  v_cvt_pk_bf16_f32 v120, v68, v69
  v_cvt_pk_bf16_f32 v121, v70, v71
  v_pk_mul_f32 v[72:73], v[72:73], v[230:231] op_sel_hi:[1,0]
  v_pk_mul_f32 v[74:75], v[74:75], v[230:231] op_sel_hi:[1,0]
  v_cvt_pk_bf16_f32 v216, v64, v65
  buffer_load_dwordx4 a[172:175], v2, s[28:31], s98 offen offset:3072 sc1
  v_cvt_pk_bf16_f32 v217, v66, v67
  v_cvt_pk_bf16_f32 v164, v72, v73
  v_cvt_pk_bf16_f32 v165, v74, v75
  ds_write_b128 v101, v[156:159]
  ds_write_b128 v102, v[160:163]
  ds_write_b128 v103, v[164:167]
  s_call_b64 s[80:81], L_smx
  s_nop 1
  ds_write_b128 v246, v[196:199]
  ds_write_b128 v97, v[200:203]
  ds_write_b128 v98, v[204:207]
  ds_write_b128 v99, v[208:211]
  ds_write_b128 v100, v[212:215]
  s_waitcnt vmcnt(16) lgkmcnt(0)
  s_barrier
  ds_read_b64_tr_b16 v[112:113], v247 offset:0
  ds_read_b64_tr_b16 v[114:115], v248 offset:512
  ds_read_b64_tr_b16 v[116:117], v249 offset:0
  ds_read_b64_tr_b16 v[118:119], v250 offset:512
  ds_read_b64_tr_b16 v[120:121], v247 offset:2048
  ds_read_b64_tr_b16 v[122:123], v248 offset:2560
  ds_read_b64_tr_b16 v[124:125], v249 offset:2048
  ds_read_b64_tr_b16 v[126:127], v250 offset:2560
  ds_read_b64_tr_b16 v[128:129], v247 offset:4096
  ds_read_b64_tr_b16 v[130:131], v248 offset:4608
  ds_read_b64_tr_b16 v[132:133], v249 offset:4096
  ds_read_b64_tr_b16 v[134:135], v250 offset:4608
  s_waitcnt lgkmcnt(8)
  v_mfma_f32_32x32x16_bf16 v[48:63], v[112:115], v[116:119], 0
  ds_read_b64_tr_b16 v[136:137], v247 offset:6144
  ds_read_b64_tr_b16 v[138:139], v248 offset:6656
  ds_read_b64_tr_b16 v[140:141], v249 offset:6144
  ds_read_b64_tr_b16 v[142:143], v250 offset:6656
  s_waitcnt lgkmcnt(8)
  v_mfma_f32_32x32x16_bf16 v[48:63], v[120:123], v[124:127], v[48:63]
  ds_read_b64_tr_b16 v[144:145], v247 offset:8192
  ds_read_b64_tr_b16 v[146:147], v248 offset:8704
  ds_read_b64_tr_b16 v[148:149], v249 offset:8192
  ds_read_b64_tr_b16 v[150:151], v250 offset:8704
  s_waitcnt lgkmcnt(8)
  v_mfma_f32_32x32x16_bf16 v[48:63], v[128:131], v[132:135], v[48:63]
  ds_read_b64_tr_b16 v[152:153], v247 offset:10240
  ds_read_b64_tr_b16 v[154:155], v248 offset:10752
  ds_read_b64_tr_b16 v[156:157], v249 offset:10240
  ds_read_b64_tr_b16 v[158:159], v250 offset:10752
  s_waitcnt lgkmcnt(8)
  v_mfma_f32_32x32x16_bf16 v[48:63], v[136:139], v[140:143], v[48:63]
  ds_read_b64_tr_b16 v[160:161], v247 offset:12288
  ds_read_b64_tr_b16 v[162:163], v248 offset:12800
  ds_read_b64_tr_b16 v[164:165], v249 offset:12288
  ds_read_b64_tr_b16 v[166:167], v250 offset:12800
  s_waitcnt lgkmcnt(8)
  v_mfma_f32_32x32x16_bf16 v[48:63], v[144:147], v[148:151], v[48:63]
  ds_read_b64_tr_b16 v[168:169], v247 offset:14336
  ds_read_b64_tr_b16 v[170:171], v248 offset:14848
  ds_read_b64_tr_b16 v[172:173], v249 offset:14336
  ds_read_b64_tr_b16 v[174:175], v250 offset:14848
  s_waitcnt lgkmcnt(8)
  v_mfma_f32_32x32x16_bf16 v[48:63], v[152:155], v[156:159], v[48:63]
  s_waitcnt lgkmcnt(4)
  v_mfma_f32_32x32x16_bf16 v[48:63], v[160:163], v[164:167], v[48:63]
  s_waitcnt lgkmcnt(0)
  v_mfma_f32_32x32x16_bf16 v[48:63], v[168:171], v[172:175], v[48:63]
  ds_read_b128 v[176:179], v3 offset:57344
  ds_read_b128 v[180:183], v3 offset:58368
  ds_read_b128 v[184:187], v3 offset:59392
  ds_read_b128 v[188:191], v3 offset:60416
  ds_read_b128 v[192:195], v3 offset:61440
  ds_read_b128 v[196:199], v3 offset:62464
  ds_read_b128 v[200:203], v3 offset:63488
  ds_read_b128 v[204:207], v3 offset:64512
  s_cmp_eq_u32 s6, 1
  s_mov_b32 s55, 0xffffff
  s_cselect_b32 s56, 0, s55
  s_nop 0
  v_cvt_pk_bf16_f32 v48, v48, v49
  v_cvt_pk_bf16_f32 v49, v50, v51
  v_cvt_pk_bf16_f32 v50, v52, v53
  v_cvt_pk_bf16_f32 v51, v54, v55
  v_cvt_pk_bf16_f32 v52, v56, v57
  v_cvt_pk_bf16_f32 v53, v58, v59
  v_cvt_pk_bf16_f32 v54, v60, v61
  v_cvt_pk_bf16_f32 v55, v62, v63
  v_permlane32_swap_b32 v48, v50
  v_permlane32_swap_b32 v49, v51
  v_permlane32_swap_b32 v52, v54
  v_permlane32_swap_b32 v53, v55
  s_mov_b32 exec_lo, s55
  s_mov_b32 exec_hi, s56
  buffer_store_dwordx4 v[48:51], v251, s[28:31], s3 offen sc1
  s_cbranch_scc1 L_kvst_13
  buffer_store_dwordx4 v[52:55], v251, s[28:31], s3 offen offset:768 sc1
L_kvst_13:
  s_mov_b64 exec, -1
  s_waitcnt lgkmcnt(7)
  s_add_u32 s98, s92, 4096
  buffer_load_dwordx4 a[176:179], v2, s[28:31], s98 offen offset:0 sc1
  v_mfma_f32_32x32x16_bf16 v[80:95], v[176:179], a[0:3], 0
  ds_read_b128 v[208:211], v4 offset:0
  s_waitcnt lgkmcnt(7)
  v_mfma_f32_32x32x16_bf16 v[80:95], v[180:183], a[4:7], v[80:95]
  ds_read_b128 v[212:215], v4 offset:1024
  s_waitcnt lgkmcnt(7)
  v_mfma_f32_32x32x16_bf16 v[80:95], v[184:187], a[8:11], v[80:95]
  s_add_u32 s98, s92, 20480
  buffer_load_dwordx4 a[180:183], v2, s[28:31], s98 offen offset:0 sc1
  ds_read_b128 v[176:179], v4 offset:2048
  s_waitcnt lgkmcnt(7)
  v_mfma_f32_32x32x16_bf16 v[80:95], v[188:191], a[12:15], v[80:95]
  ds_read_b128 v[180:183], v4 offset:3072
  s_waitcnt lgkmcnt(7)
  v_mfma_f32_32x32x16_bf16 v[80:95], v[192:195], a[16:19], v[80:95]
  buffer_load_dwordx4 a[184:187], v2, s[28:31], s98 offen offset:1024 sc1
  ds_read_b128 v[184:187], v4 offset:4096
  s_waitcnt lgkmcnt(7)
  v_mfma_f32_32x32x16_bf16 v[80:95], v[196:199], a[20:23], v[80:95]
  ds_read_b128 v[188:191], v4 offset:5120
  s_waitcnt lgkmcnt(7)
  v_mfma_f32_32x32x16_bf16 v[80:95], v[200:203], a[24:27], v[80:95]
  ds_read_b128 v[192:195], v4 offset:6144
  s_waitcnt lgkmcnt(7)
  v_mfma_f32_32x32x16_bf16 v[80:95], v[204:207], a[28:31], v[80:95]
  buffer_load_dwordx4 a[188:191], v2, s[28:31], s98 offen offset:2048 sc1
  ds_read_b128 v[196:199], v4 offset:7168
  s_waitcnt lgkmcnt(7)
  v_mfma_f32_32x32x16_bf16 v[80:95], v[208:211], a[32:35], v[80:95]
  ds_read_b128 v[200:203], v4 offset:8192
  s_waitcnt lgkmcnt(7)
  v_mfma_f32_32x32x16_bf16 v[80:95], v[212:215], a[36:39], v[80:95]
  buffer_load_dwordx4 a[192:195], v2, s[28:31], s98 offen offset:3072 sc1
  ds_read_b128 v[204:207], v4 offset:9216
  s_waitcnt lgkmcnt(7)
  v_mfma_f32_32x32x16_bf16 v[80:95], v[176:179], a[40:43], v[80:95]
  ds_read_b128 v[208:211], v4 offset:10240
  s_waitcnt lgkmcnt(7)
  v_mfma_f32_32x32x16_bf16 v[80:95], v[180:183], a[44:47], v[80:95]
  ds_read_b128 v[212:215], v4 offset:11264
  s_lshl_b32 s58, s83, 7
  s_add_u32 s58, s58, 24309760
  s_lshl_b32 s59, s82, 2
  v_mov_b32 v6, s59
  v_mov_b32 v7, s51
  s_cmp_lg_u32 s48, 0
  s_waitcnt vmcnt(5)
  s_barrier
  s_cbranch_scc1 L_sig_14
  s_mov_b64 exec, 1
  buffer_store_dword v7, v6, s[28:31], s58 offen sc1
  s_mov_b64 exec, -1
L_sig_14:
  s_waitcnt lgkmcnt(7)
  s_add_u32 s98, s92, 24576
  buffer_load_dwordx4 a[196:199], v2, s[28:31], s98 offen offset:0 sc1
  v_mfma_f32_32x32x16_bf16 v[80:95], v[184:187], a[48:51], v[80:95]
  ds_read_b128 v[176:179], v4 offset:12288
  s_waitcnt lgkmcnt(7)
  v_mfma_f32_32x32x16_bf16 v[80:95], v[188:191], a[52:55], v[80:95]
  ds_read_b128 v[180:183], v4 offset:13312
  s_waitcnt lgkmcnt(7)
  v_mfma_f32_32x32x16_bf16 v[80:95], v[192:195], a[56:59], v[80:95]
  s_add_u32 s98, s92, 40960
  buffer_load_dwordx4 a[200:203], v2, s[28:31], s98 offen offset:0 sc1
  ds_read_b128 v[184:187], v4 offset:14336
  s_waitcnt lgkmcnt(7)
  v_mfma_f32_32x32x16_bf16 v[80:95], v[196:199], a[60:63], v[80:95]
  ds_read_b128 v[188:191], v4 offset:15360
  s_waitcnt lgkmcnt(7)
  v_mfma_f32_32x32x16_bf16 v[80:95], v[200:203], a[64:67], v[80:95]
  buffer_load_dwordx4 a[204:207], v2, s[28:31], s98 offen offset:1024 sc1
  ds_read_b128 v[192:195], v4 offset:16384
  s_waitcnt lgkmcnt(7)
  v_mfma_f32_32x32x16_bf16 v[80:95], v[204:207], a[68:71], v[80:95]
  ds_read_b128 v[196:199], v4 offset:17408
  s_waitcnt lgkmcnt(7)
  v_mfma_f32_32x32x16_bf16 v[80:95], v[208:211], a[72:75], v[80:95]
  ds_read_b128 v[200:203], v4 offset:18432
  s_waitcnt lgkmcnt(7)
  v_mfma_f32_32x32x16_bf16 v[80:95], v[212:215], a[76:79], v[80:95]
  buffer_load_dwordx4 a[208:211], v2, s[28:31], s98 offen offset:2048 sc1
  ds_read_b128 v[204:207], v4 offset:19456
  s_waitcnt lgkmcnt(7)
  v_mfma_f32_32x32x16_bf16 v[80:95], v[176:179], a[80:83], v[80:95]
  ds_read_b128 v[208:211], v4 offset:20480
  s_waitcnt lgkmcnt(7)
  v_mfma_f32_32x32x16_bf16 v[80:95], v[180:183], a[84:87], v[80:95]
  buffer_load_dwordx4 a[212:215], v2, s[28:31], s98 offen offset:3072 sc1
  ds_read_b128 v[212:215], v4 offset:21504
  s_waitcnt lgkmcnt(7)
  v_mfma_f32_32x32x16_bf16 v[80:95], v[184:187], a[88:91], v[80:95]
  ds_read_b128 v[176:179], v4 offset:22528
  s_waitcnt lgkmcnt(7)
  v_mfma_f32_32x32x16_bf16 v[80:95], v[188:191], a[92:95], v[80:95]
  ds_read_b128 v[180:183], v4 offset:23552
  s_waitcnt lgkmcnt(7)
  v_mfma_f32_32x32x16_bf16 v[80:95], v[192:195], a[96:99], v[80:95]
  s_add_u32 s98, s92, 45056
  buffer_load_dwordx4 a[216:219], v2, s[28:31], s98 offen offset:0 sc1
  ds_read_b128 v[184:187], v4 offset:24576
  s_waitcnt lgkmcnt(7)
  v_mfma_f32_32x32x16_bf16 v[80:95], v[196:199], a[100:103], v[80:95]
  ds_read_b128 v[188:191], v4 offset:25600
  s_waitcnt lgkmcnt(7)
  v_mfma_f32_32x32x16_bf16 v[80:95], v[200:203], a[104:107], v[80:95]
  s_add_u32 s98, s92, 61440
  buffer_load_dwordx4 a[220:223], v2, s[28:31], s98 offen offset:0 sc1
  ds_read_b128 v[192:195], v4 offset:26624
  s_waitcnt lgkmcnt(7)
  v_mfma_f32_32x32x16_bf16 v[80:95], v[204:207], a[108:111], v[80:95]
  ds_read_b128 v[196:199], v4 offset:27648
  s_waitcnt lgkmcnt(7)
  v_mfma_f32_32x32x16_bf16 v[80:95], v[208:211], a[112:115], v[80:95]
  ds_read_b128 v[200:203], v4 offset:28672
  s_waitcnt lgkmcnt(7)
  v_mfma_f32_32x32x16_bf16 v[80:95], v[212:215], a[116:119], v[80:95]
  buffer_load_dwordx4 a[224:227], v2, s[28:31], s98 offen offset:1024 sc1
  ds_read_b128 v[204:207], v4 offset:29696
  s_waitcnt lgkmcnt(7)
  v_mfma_f32_32x32x16_bf16 v[80:95], v[176:179], a[120:123], v[80:95]
  ds_read_b128 v[208:211], v4 offset:30720
  s_waitcnt lgkmcnt(7)
  v_mfma_f32_32x32x16_bf16 v[80:95], v[180:183], a[124:127], v[80:95]
  buffer_load_dwordx4 a[228:231], v2, s[28:31], s98 offen offset:2048 sc1
  ds_read_b128 v[212:215], v4 offset:31744
  s_waitcnt lgkmcnt(7)
  v_mfma_f32_32x32x16_bf16 v[80:95], v[184:187], a[128:131], v[80:95]
  s_waitcnt lgkmcnt(6)
  v_mfma_f32_32x32x16_bf16 v[80:95], v[188:191], a[132:135], v[80:95]
  s_waitcnt lgkmcnt(5)
  v_mfma_f32_32x32x16_bf16 v[80:95], v[192:195], a[136:139], v[80:95]
  buffer_load_dwordx4 a[232:235], v2, s[28:31], s98 offen offset:3072 sc1
  s_waitcnt lgkmcnt(4)
  v_mfma_f32_32x32x16_bf16 v[80:95], v[196:199], a[140:143], v[80:95]
  s_waitcnt lgkmcnt(3)
  v_mfma_f32_32x32x16_bf16 v[80:95], v[200:203], a[144:147], v[80:95]
  s_add_u32 s98, s92, 65536
  buffer_load_dwordx4 a[236:239], v2, s[28:31], s98 offen offset:0 sc1
  s_waitcnt lgkmcnt(2)
  v_mfma_f32_32x32x16_bf16 v[80:95], v[204:207], a[148:151], v[80:95]
  s_waitcnt lgkmcnt(1)
  v_mfma_f32_32x32x16_bf16 v[80:95], v[208:211], a[152:155], v[80:95]
  s_waitcnt lgkmcnt(0)
  v_mfma_f32_32x32x16_bf16 v[80:95], v[212:215], a[156:159], v[80:95]
  s_add_u32 s98, s92, 81920
  buffer_load_dwordx4 a[240:243], v2, s[28:31], s98 offen offset:0 sc1
  v_mfma_f32_32x32x16_bf16 v[80:95], v[108:111], v[236:239], v[80:95]
  s_barrier
  v_mov_b32 v32, 0
  v_mov_b32 v33, 0
  v_mov_b32 v120, v216
  v_mov_b32 v121, v217
  v_mov_b32 v122, 0
  v_mov_b32 v123, 0
  ds_write_b64 v255, v[32:33] offset:0
  ds_write_b64 v255, v[32:33] offset:8
  ds_write_b64 v255, v[32:33] offset:16
  ds_write_b64 v255, v[32:33] offset:24
  ds_write_b64 v255, v[32:33] offset:32
  v_cvt_pk_bf16_f32 v112, v80, v81
  v_cvt_pk_bf16_f32 v113, v82, v83
  v_cvt_pk_bf16_f32 v114, v84, v85
  v_cvt_pk_bf16_f32 v115, v86, v87
  v_cvt_pk_bf16_f32 v116, v88, v89
  v_cvt_pk_bf16_f32 v117, v90, v91
  v_cvt_pk_bf16_f32 v118, v92, v93
  v_cvt_pk_bf16_f32 v119, v94, v95
  s_call_b64 s[80:81], L_smx
  s_nop 1
  v_mov_b32 v32, 0
  v_mov_b32 v33, 0
  v_mov_b32 v34, 0
  v_mov_b32 v35, 0
  v_mov_b32 v36, 0
  v_mov_b32 v37, 0
  v_mov_b32 v38, 0
  v_mov_b32 v39, 0
  s_mov_b32 s86, 0x3f80
  s_mov_b32 s87, 0x3f800000
  s_waitcnt lgkmcnt(0)
  buffer_load_dwordx4 a[244:247], v2, s[28:31], s98 offen offset:1024 sc1
  buffer_load_dwordx4 a[248:251], v2, s[28:31], s98 offen offset:2048 sc1
  buffer_load_dwordx4 a[252:255], v2, s[28:31], s98 offen offset:3072 sc1
  s_add_u32 s98, s92, 86016
  buffer_load_dwordx4 v[240:243], v2, s[28:31], s98 offen offset:0 sc1
  s_mov_b32 m0, s89
  s_nop 0
  buffer_load_dwordx4 v2, s[44:47], s89 offen sc1 lds
  s_add_u32 s89, s89, 4096
  s_add_u32 s99, s93, 0
  buffer_load_dwordx4 a[0:3], v2, s[28:31], s99 offen offset:0 sc1
  s_add_u32 s99, s93, 0
  buffer_load_dwordx4 a[20:23], v2, s[28:31], s99 offen offset:1024 sc1
  s_add_u32 s99, s93, 55296
  buffer_load_dwordx4 a[4:7], v2, s[28:31], s99 offen offset:0 sc1
  s_cmp_lg_u32 s48, 0
  s_cbranch_scc1 L_wt_15
  s_lshl_b32 s58, s83, 7
  s_add_u32 s58, s58, 24309760
  v_lshlrev_b32 v6, 2, v1
  s_mov_b64 exec, 0xffff
  s_mov_b32 s57, 0
L_poll_16:
  buffer_load_dword v7, v6, s[28:31], s58 offen sc1
  s_add_u32 s57, s57, 1
  s_waitcnt vmcnt(0)
  v_cmp_ne_u32 vcc, s51, v7
  s_cmp_ge_u32 s57, 32768
  s_cbranch_scc1 L_pd_17
  s_cbranch_vccnz L_poll_16
L_pd_17:
  s_mov_b64 exec, -1
L_wt_15:
  s_barrier
  buffer_load_dwordx4 v[40:43], v252, s[28:31], s4 offen sc1
  s_add_u32 s4, s4, 3840
  buffer_load_dwordx4 v[44:47], v252, s[28:31], s4 offen sc1
  s_add_u32 s4, s4, 3840
  buffer_load_dwordx4 v[48:51], v252, s[28:31], s4 offen sc1
  s_add_u32 s4, s4, 3840
  buffer_load_dwordx4 v[52:55], v252, s[28:31], s4 offen sc1
  s_add_u32 s4, s4, 3840
  buffer_load_dwordx4 v[56:59], v252, s[28:31], s4 offen sc1
  s_add_u32 s4, s4, 3840
  buffer_load_dwordx4 v[60:63], v252, s[28:31], s4 offen sc1
  s_add_u32 s4, s4, 3840
  buffer_load_dwordx4 v[64:67], v252, s[28:31], s4 offen sc1
  s_add_u32 s4, s4, 3840
  buffer_load_dwordx4 v[68:71], v252, s[28:31], s4 offen sc1
  s_add_u32 s4, s4, 3840
  buffer_load_dwordx4 v[72:75], v252, s[28:31], s4 offen sc1
  s_add_u32 s4, s4, 3840
  buffer_load_dwordx4 v[76:79], v252, s[28:31], s4 offen sc1
  s_add_u32 s4, s4, 3840
  buffer_load_dwordx4 v[80:83], v252, s[28:31], s4 offen sc1
  s_add_u32 s4, s4, 3840
  buffer_load_dwordx4 v[84:87], v252, s[28:31], s4 offen sc1
  s_add_u32 s4, s4, 3840
  buffer_load_dwordx4 v[88:91], v252, s[28:31], s4 offen sc1
  s_add_u32 s4, s4, 3840
  buffer_load_dwordx4 v[92:95], v252, s[28:31], s4 offen sc1
  s_add_u32 s4, s4, 3840
  buffer_load_dwordx4 v[96:99], v252, s[28:31], s4 offen sc1
  s_add_u32 s4, s4, 3840
  buffer_load_dwordx4 v[100:103], v252, s[28:31], s4 offen sc1
  s_add_u32 s99, s93, 55296
  buffer_load_dwordx4 a[24:27], v2, s[28:31], s99 offen offset:1024 sc1
  s_add_u32 s99, s93, 110592
  buffer_load_dwordx4 a[8:11], v2, s[28:31], s99 offen offset:0 sc1
  s_add_u32 s99, s93, 110592
  buffer_load_dwordx4 a[28:31], v2, s[28:31], s99 offen offset:1024 sc1
  s_add_u32 s99, s93, 165888
  buffer_load_dwordx4 a[12:15], v2, s[28:31], s99 offen offset:0 sc1
  s_add_u32 s99, s93, 165888
  buffer_load_dwordx4 a[32:35], v2, s[28:31], s99 offen offset:1024 sc1
  s_add_u32 s99, s93, 221184
  buffer_load_dwordx4 a[16:19], v2, s[28:31], s99 offen offset:0 sc1
  s_add_u32 s99, s93, 221184
  buffer_load_dwordx4 a[36:39], v2, s[28:31], s99 offen offset:1024 sc1
  s_add_u32 s99, s93, 0
  buffer_load_dwordx4 a[40:43], v2, s[28:31], s99 offen offset:2048 sc1
  s_add_u32 s99, s93, 0
  buffer_load_dwordx4 a[60:63], v2, s[28:31], s99 offen offset:3072 sc1
  s_add_u32 s99, s93, 55296
  buffer_load_dwordx4 a[44:47], v2, s[28:31], s99 offen offset:2048 sc1
  s_waitcnt vmcnt(25)
  v_dot2c_f32_bf16 v32, s86, v40
  v_dot2c_f32_bf16 v33, s87, v40
  v_dot2c_f32_bf16 v34, s86, v41
  v_dot2c_f32_bf16 v35, s87, v41
  v_dot2c_f32_bf16 v36, s86, v42
  v_dot2c_f32_bf16 v37, s87, v42
  v_dot2c_f32_bf16 v38, s86, v43
  v_dot2c_f32_bf16 v39, s87, v43
  s_waitcnt vmcnt(24)
  v_dot2c_f32_bf16 v32, s86, v44
  v_dot2c_f32_bf16 v33, s87, v44
  v_dot2c_f32_bf16 v34, s86, v45
  v_dot2c_f32_bf16 v35, s87, v45
  v_dot2c_f32_bf16 v36, s86, v46
  v_dot2c_f32_bf16 v37, s87, v46
  v_dot2c_f32_bf16 v38, s86, v47
  v_dot2c_f32_bf16 v39, s87, v47
  s_waitcnt vmcnt(23)
  v_dot2c_f32_bf16 v32, s86, v48
  v_dot2c_f32_bf16 v33, s87, v48
  v_dot2c_f32_bf16 v34, s86, v49
  v_dot2c_f32_bf16 v35, s87, v49
  v_dot2c_f32_bf16 v36, s86, v50
  v_dot2c_f32_bf16 v37, s87, v50
  v_dot2c_f32_bf16 v38, s86, v51
  v_dot2c_f32_bf16 v39, s87, v51
  s_waitcnt vmcnt(22)
  v_dot2c_f32_bf16 v32, s86, v52
  v_dot2c_f32_bf16 v33, s87, v52
  v_dot2c_f32_bf16 v34, s86, v53
  v_dot2c_f32_bf16 v35, s87, v53
  v_dot2c_f32_bf16 v36, s86, v54
  v_dot2c_f32_bf16 v37, s87, v54
  v_dot2c_f32_bf16 v38, s86, v55
  v_dot2c_f32_bf16 v39, s87, v55
  s_waitcnt vmcnt(21)
  v_dot2c_f32_bf16 v32, s86, v56
  v_dot2c_f32_bf16 v33, s87, v56
  v_dot2c_f32_bf16 v34, s86, v57
  v_dot2c_f32_bf16 v35, s87, v57
  v_dot2c_f32_bf16 v36, s86, v58
  v_dot2c_f32_bf16 v37, s87, v58
  v_dot2c_f32_bf16 v38, s86, v59
  v_dot2c_f32_bf16 v39, s87, v59
  s_waitcnt vmcnt(20)
  v_dot2c_f32_bf16 v32, s86, v60
  v_dot2c_f32_bf16 v33, s87, v60
  v_dot2c_f32_bf16 v34, s86, v61
  v_dot2c_f32_bf16 v35, s87, v61
  v_dot2c_f32_bf16 v36, s86, v62
  v_dot2c_f32_bf16 v37, s87, v62
  v_dot2c_f32_bf16 v38, s86, v63
  v_dot2c_f32_bf16 v39, s87, v63
  s_waitcnt vmcnt(19)
  v_dot2c_f32_bf16 v32, s86, v64
  v_dot2c_f32_bf16 v33, s87, v64
  v_dot2c_f32_bf16 v34, s86, v65
  v_dot2c_f32_bf16 v35, s87, v65
  v_dot2c_f32_bf16 v36, s86, v66
  v_dot2c_f32_bf16 v37, s87, v66
  v_dot2c_f32_bf16 v38, s86, v67
  v_dot2c_f32_bf16 v39, s87, v67
  s_waitcnt vmcnt(18)
  v_dot2c_f32_bf16 v32, s86, v68
  v_dot2c_f32_bf16 v33, s87, v68
  v_dot2c_f32_bf16 v34, s86, v69
  v_dot2c_f32_bf16 v35, s87, v69
  v_dot2c_f32_bf16 v36, s86, v70
  v_dot2c_f32_bf16 v37, s87, v70
  v_dot2c_f32_bf16 v38, s86, v71
  v_dot2c_f32_bf16 v39, s87, v71
  s_waitcnt vmcnt(17)
  v_dot2c_f32_bf16 v32, s86, v72
  v_dot2c_f32_bf16 v33, s87, v72
  v_dot2c_f32_bf16 v34, s86, v73
  v_dot2c_f32_bf16 v35, s87, v73
  v_dot2c_f32_bf16 v36, s86, v74
  v_dot2c_f32_bf16 v37, s87, v74
  v_dot2c_f32_bf16 v38, s86, v75
  v_dot2c_f32_bf16 v39, s87, v75
  s_waitcnt vmcnt(16)
  v_dot2c_f32_bf16 v32, s86, v76
  v_dot2c_f32_bf16 v33, s87, v76
  v_dot2c_f32_bf16 v34, s86, v77
  v_dot2c_f32_bf16 v35, s87, v77
  v_dot2c_f32_bf16 v36, s86, v78
  v_dot2c_f32_bf16 v37, s87, v78
  v_dot2c_f32_bf16 v38, s86, v79
  v_dot2c_f32_bf16 v39, s87, v79
  s_waitcnt vmcnt(15)
  v_dot2c_f32_bf16 v32, s86, v80
  v_dot2c_f32_bf16 v33, s87, v80
  v_dot2c_f32_bf16 v34, s86, v81
  v_dot2c_f32_bf16 v35, s87, v81
  v_dot2c_f32_bf16 v36, s86, v82
  v_dot2c_f32_bf16 v37, s87, v82
  v_dot2c_f32_bf16 v38, s86, v83
  v_dot2c_f32_bf16 v39, s87, v83
  s_waitcnt vmcnt(14)
  v_dot2c_f32_bf16 v32, s86, v84
  v_dot2c_f32_bf16 v33, s87, v84
  v_dot2c_f32_bf16 v34, s86, v85
  v_dot2c_f32_bf16 v35, s87, v85
  v_dot2c_f32_bf16 v36, s86, v86
  v_dot2c_f32_bf16 v37, s87, v86
  v_dot2c_f32_bf16 v38, s86, v87
  v_dot2c_f32_bf16 v39, s87, v87
  s_waitcnt vmcnt(13)
  v_dot2c_f32_bf16 v32, s86, v88
  v_dot2c_f32_bf16 v33, s87, v88
  v_dot2c_f32_bf16 v34, s86, v89
  v_dot2c_f32_bf16 v35, s87, v89
  v_dot2c_f32_bf16 v36, s86, v90
  v_dot2c_f32_bf16 v37, s87, v90
  v_dot2c_f32_bf16 v38, s86, v91
  v_dot2c_f32_bf16 v39, s87, v91
  s_waitcnt vmcnt(12)
  v_dot2c_f32_bf16 v32, s86, v92
  v_dot2c_f32_bf16 v33, s87, v92
  v_dot2c_f32_bf16 v34, s86, v93
  v_dot2c_f32_bf16 v35, s87, v93
  v_dot2c_f32_bf16 v36, s86, v94
  v_dot2c_f32_bf16 v37, s87, v94
  v_dot2c_f32_bf16 v38, s86, v95
  v_dot2c_f32_bf16 v39, s87, v95
  s_waitcnt vmcnt(11)
  v_dot2c_f32_bf16 v32, s86, v96
  v_dot2c_f32_bf16 v33, s87, v96
  v_dot2c_f32_bf16 v34, s86, v97
  v_dot2c_f32_bf16 v35, s87, v97
  v_dot2c_f32_bf16 v36, s86, v98
  v_dot2c_f32_bf16 v37, s87, v98
  v_dot2c_f32_bf16 v38, s86, v99
  v_dot2c_f32_bf16 v39, s87, v99
  s_waitcnt vmcnt(10)
  v_dot2c_f32_bf16 v32, s86, v100
  v_dot2c_f32_bf16 v33, s87, v100
  v_dot2c_f32_bf16 v34, s86, v101
  v_dot2c_f32_bf16 v35, s87, v101
  v_dot2c_f32_bf16 v36, s86, v102
  v_dot2c_f32_bf16 v37, s87, v102
  v_dot2c_f32_bf16 v38, s86, v103
  v_dot2c_f32_bf16 v39, s87, v103
  v_cvt_pk_bf16_f32 v40, v32, v33
  v_cvt_pk_bf16_f32 v41, v34, v35
  v_cvt_pk_bf16_f32 v42, v36, v37
  v_cvt_pk_bf16_f32 v43, v38, v39
  ds_write_b128 v253, v[40:43]
  s_waitcnt lgkmcnt(0)
  s_barrier
  ds_read_b128 v[40:43], v4 offset:22528
  ds_read_b128 v[60:63], v4 offset:27648
  ds_read_b128 v[44:47], v4 offset:23552
  ds_read_b128 v[64:67], v4 offset:28672
  ds_read_b128 v[48:51], v4 offset:24576
  ds_read_b128 v[68:71], v4 offset:29696
  ds_read_b128 v[52:55], v4 offset:25600
  ds_read_b128 v[72:75], v4 offset:30720
  ds_read_b128 v[56:59], v4 offset:26624
  ds_read_b128 v[76:79], v4 offset:31744
  s_waitcnt lgkmcnt(9)
  v_mfma_f32_32x32x16_bf16 v[96:111], v[40:43], v[196:199], 0
  s_waitcnt lgkmcnt(8)
  v_mfma_f32_32x32x16_bf16 v[112:127], v[60:63], v[196:199], 0
  s_waitcnt lgkmcnt(7)
  v_mfma_f32_32x32x16_bf16 v[96:111], v[44:47], v[200:203], v[96:111]
  s_waitcnt lgkmcnt(6)
  v_mfma_f32_32x32x16_bf16 v[112:127], v[64:67], v[200:203], v[112:127]
  s_waitcnt lgkmcnt(5)
  v_mfma_f32_32x32x16_bf16 v[96:111], v[48:51], v[204:207], v[96:111]
  s_waitcnt lgkmcnt(4)
  v_mfma_f32_32x32x16_bf16 v[112:127], v[68:71], v[204:207], v[112:127]
  s_waitcnt lgkmcnt(3)
  v_mfma_f32_32x32x16_bf16 v[96:111], v[52:55], v[208:211], v[96:111]
  s_waitcnt lgkmcnt(2)
  v_mfma_f32_32x32x16_bf16 v[112:127], v[72:75], v[208:211], v[112:127]
  s_waitcnt lgkmcnt(1)
  v_mfma_f32_32x32x16_bf16 v[96:111], v[56:59], v[212:215], v[96:111]
  s_waitcnt lgkmcnt(0)
  v_mfma_f32_32x32x16_bf16 v[112:127], v[76:79], v[212:215], v[112:127]
  s_nop 11
  v_add_f32 v34, 0x358637bd, v116
  v_rcp_f32 v34, v34
  s_nop 0
  v_pk_mul_f32 v[96:97], v[96:97], v[34:35] op_sel_hi:[1,0]
  v_pk_mul_f32 v[98:99], v[98:99], v[34:35] op_sel_hi:[1,0]
  v_pk_mul_f32 v[100:101], v[100:101], v[34:35] op_sel_hi:[1,0]
  v_pk_mul_f32 v[102:103], v[102:103], v[34:35] op_sel_hi:[1,0]
  v_pk_mul_f32 v[104:105], v[104:105], v[34:35] op_sel_hi:[1,0]
  v_pk_mul_f32 v[106:107], v[106:107], v[34:35] op_sel_hi:[1,0]
  v_pk_mul_f32 v[108:109], v[108:109], v[34:35] op_sel_hi:[1,0]
  v_pk_mul_f32 v[110:111], v[110:111], v[34:35] op_sel_hi:[1,0]
  v_pk_mul_f32 v[112:113], v[112:113], v[34:35] op_sel_hi:[1,0]
  v_pk_mul_f32 v[114:115], v[114:115], v[34:35] op_sel_hi:[1,0]
  v_cvt_pk_bf16_f32 v40, v96, v97
  v_cvt_pk_bf16_f32 v41, v98, v99
  v_cvt_pk_bf16_f32 v42, v100, v101
  v_cvt_pk_bf16_f32 v43, v102, v103
  v_cvt_pk_bf16_f32 v44, v104, v105
  v_cvt_pk_bf16_f32 v45, v106, v107
  v_cvt_pk_bf16_f32 v46, v108, v109
  v_cvt_pk_bf16_f32 v47, v110, v111
  v_cvt_pk_bf16_f32 v48, v112, v113
  v_cvt_pk_bf16_f32 v49, v114, v115
  buffer_store_dwordx4 v[40:43], v254, s[28:31], s5 offen sc1
  buffer_store_dwordx4 v[44:47], v254, s[28:31], s5 offen offset:256 sc1
  v_permlane32_swap_b32 v48, v50
  v_permlane32_swap_b32 v49, v51
  s_mov_b64 exec, 0xffffffff
  buffer_store_dwordx4 v[48:51], v254, s[28:31], s5 offen offset:512 sc1
  s_mov_b64 exec, -1
  s_lshr_b32 s62, s50, 1
  s_and_b32 s63, s50, 1
  s_lshl_b32 s64, s49, 3
  s_lshl_b32 s55, s63, 2
  s_add_u32 s64, s64, s55
  s_add_u32 s65, s64, s48
  s_mul_i32 s61, s65, 20480
  s_mul_i32 s55, s62, 160
  s_add_u32 s61, s61, s55
  v_and_b32 v8, 15, v1
  v_lshrrev_b32 v9, 4, v1
  v_mul_u32_u24 v8, 1280, v8
  v_lshl_add_u32 v8, v9, 3, v8
  s_lshl_b32 s58, s82, 7
  s_add_u32 s58, s58, 24317952
  s_lshl_b32 s59, s83, 2
  v_mov_b32 v6, s59
  v_mov_b32 v7, s51
  s_cmp_lg_u32 s48, 0
  s_waitcnt vmcnt(0)
  s_barrier
  s_cbranch_scc1 L_sig_18
  s_mov_b64 exec, 1
  buffer_store_dword v7, v6, s[28:31], s58 offen sc1
  s_mov_b64 exec, -1
L_sig_18:
  buffer_load_dwordx2 v[230:231], v8, s[32:35], s61 offen offset:0
  buffer_load_dwordx2 v[232:233], v8, s[32:35], s61 offen offset:32
  buffer_load_dwordx2 v[234:235], v8, s[32:35], s61 offen offset:64
  buffer_load_dwordx2 v[236:237], v8, s[32:35], s61 offen offset:96
  buffer_load_dwordx2 v[238:239], v8, s[32:35], s61 offen offset:128
  s_add_u32 s99, s93, 55296
  buffer_load_dwordx4 a[64:67], v2, s[28:31], s99 offen offset:3072 sc1
  s_add_u32 s99, s93, 110592
  buffer_load_dwordx4 a[48:51], v2, s[28:31], s99 offen offset:2048 sc1
  s_add_u32 s99, s93, 110592
  buffer_load_dwordx4 a[68:71], v2, s[28:31], s99 offen offset:3072 sc1
  s_add_u32 s99, s93, 165888
  buffer_load_dwordx4 a[52:55], v2, s[28:31], s99 offen offset:2048 sc1
  s_add_u32 s99, s93, 165888
  buffer_load_dwordx4 a[72:75], v2, s[28:31], s99 offen offset:3072 sc1
  s_add_u32 s99, s93, 221184
  buffer_load_dwordx4 a[56:59], v2, s[28:31], s99 offen offset:2048 sc1
  s_add_u32 s99, s93, 221184
  buffer_load_dwordx4 a[76:79], v2, s[28:31], s99 offen offset:3072 sc1
  s_add_u32 s99, s93, 4096
  buffer_load_dwordx4 a[80:83], v2, s[28:31], s99 offen offset:0 sc1
  s_add_u32 s99, s93, 4096
  buffer_load_dwordx4 a[100:103], v2, s[28:31], s99 offen offset:1024 sc1
  s_add_u32 s99, s93, 59392
  buffer_load_dwordx4 a[84:87], v2, s[28:31], s99 offen offset:0 sc1
  s_add_u32 s99, s93, 59392
  buffer_load_dwordx4 a[104:107], v2, s[28:31], s99 offen offset:1024 sc1
  s_add_u32 s99, s93, 114688
  buffer_load_dwordx4 a[88:91], v2, s[28:31], s99 offen offset:0 sc1
  s_add_u32 s99, s93, 114688
  buffer_load_dwordx4 a[108:111], v2, s[28:31], s99 offen offset:1024 sc1
  s_add_u32 s99, s93, 169984
  buffer_load_dwordx4 a[92:95], v2, s[28:31], s99 offen offset:0 sc1
  s_add_u32 s55, s48, 0
  s_and_b32 s55, s55, 3
  s_add_u32 s56, s55, s64
  s_mul_i32 s66, s56, 20480
  s_mul_i32 s56, s48, 5120
  s_add_u32 s66, s66, s56
  s_add_u32 s66, s66, 6635520
  s_mul_i32 s55, s55, 15360
  s_add_u32 s55, s55, 102400
  v_add_u32 v168, s55, v2
  s_add_u32 s55, s48, 1
  s_and_b32 s55, s55, 3
  s_add_u32 s56, s55, s64
  s_mul_i32 s67, s56, 20480
  s_mul_i32 s56, s48, 5120
  s_add_u32 s67, s67, s56
  s_add_u32 s67, s67, 6635520
  s_mul_i32 s55, s55, 15360
  s_add_u32 s55, s55, 102400
  v_add_u32 v169, s55, v2
  s_add_u32 s55, s48, 2
  s_and_b32 s55, s55, 3
  s_add_u32 s56, s55, s64
  s_mul_i32 s68, s56, 20480
  s_mul_i32 s56, s48, 5120
  s_add_u32 s68, s68, s56
  s_add_u32 s68, s68, 6635520
  s_mul_i32 s55, s55, 15360
  s_add_u32 s55, s55, 107520
  v_add_u32 v170, s55, v2
  s_add_u32 s55, s48, 3
  s_and_b32 s55, s55, 3
  s_add_u32 s56, s55, s64
  s_mul_i32 s69, s56, 20480
  s_mul_i32 s56, s48, 5120
  s_add_u32 s69, s69, s56
  s_add_u32 s69, s69, 6635520
  s_mul_i32 s55, s55, 15360
  s_add_u32 s55, s55, 112640
  v_add_u32 v171, s55, v2
  s_mul_i32 s60, s65, 20480
  s_lshr_b32 s55, s62, 1
  s_mul_i32 s55, s55, 5120
  s_add_u32 s60, s60, s55
  s_add_u32 s60, s60, 9256960
  s_lshl_b32 s61, s65, 10
  s_lshl_b32 s55, s62, 7
  s_add_u32 s61, s61, s55
  s_add_u32 s61, s61, 23920640
  v_lshlrev_b32 v172, 3, v1
  v_and_b32 v173, 15, v1
  v_lshrrev_b32 v174, 5, v1
  v_lshlrev_b32 v173, 4, v173
  v_lshl_add_u32 v173, v174, 8, v173
  s_cmp_lg_u32 s48, 0
  s_cbranch_scc1 L_wt_19
  s_lshl_b32 s58, s49, 7
  s_add_u32 s58, s58, 24317952
  v_lshlrev_b32 v6, 2, v1
  s_mov_b64 exec, 0xffff
  s_mov_b32 s57, 0
L_poll_20:
  buffer_load_dword v7, v6, s[28:31], s58 offen sc1
  s_add_u32 s57, s57, 1
  s_waitcnt vmcnt(0)
  v_cmp_ne_u32 vcc, s51, v7
  s_cmp_ge_u32 s57, 32768
  s_cbranch_scc1 L_pd_21
  s_cbranch_vccnz L_poll_20
L_pd_21:
  s_mov_b64 exec, -1
L_wt_19:
  s_barrier
  buffer_load_dwordx4 v[12:15], v2, s[28:31], s67 offen offset:0 sc1
  buffer_load_dwordx4 v[16:19], v2, s[28:31], s68 offen offset:0 sc1
  buffer_load_dwordx4 v[20:23], v2, s[28:31], s69 offen offset:0 sc1
  buffer_load_dwordx4 v[28:31], v2, s[28:31], s67 offen offset:1024 sc1
  buffer_load_dwordx4 v[32:35], v2, s[28:31], s68 offen offset:1024 sc1
  buffer_load_dwordx4 v[36:39], v2, s[28:31], s69 offen offset:1024 sc1
  buffer_load_dwordx4 v[44:47], v2, s[28:31], s67 offen offset:2048 sc1
  buffer_load_dwordx4 v[48:51], v2, s[28:31], s68 offen offset:2048 sc1
  buffer_load_dwordx4 v[52:55], v2, s[28:31], s69 offen offset:2048 sc1
  buffer_load_dwordx4 v[60:63], v2, s[28:31], s67 offen offset:3072 sc1
  buffer_load_dwordx4 v[64:67], v2, s[28:31], s68 offen offset:3072 sc1
  buffer_load_dwordx4 v[68:71], v2, s[28:31], s69 offen offset:3072 sc1
  s_waitcnt vmcnt(11)
  v_mfma_f32_16x16x32_bf16 v[108:111], a[160:163], v[12:15], 0
  v_mfma_f32_16x16x32_bf16 v[112:115], a[180:183], v[12:15], 0
  s_add_u32 s55, s67, 4096
  buffer_load_dwordx4 v[76:79], v2, s[28:31], s55 offen sc1
  v_mfma_f32_16x16x32_bf16 v[116:119], a[200:203], v[12:15], 0
  v_mfma_f32_16x16x32_bf16 v[120:123], a[220:223], v[12:15], 0
  v_mfma_f32_16x16x32_bf16 v[124:127], a[240:243], v[12:15], 0
  s_waitcnt vmcnt(11)
  v_mfma_f32_16x16x32_bf16 v[128:131], a[160:163], v[16:19], 0
  v_mfma_f32_16x16x32_bf16 v[132:135], a[180:183], v[16:19], 0
  s_add_u32 s55, s68, 4096
  buffer_load_dwordx4 v[80:83], v2, s[28:31], s55 offen sc1
  v_mfma_f32_16x16x32_bf16 v[136:139], a[200:203], v[16:19], 0
  v_mfma_f32_16x16x32_bf16 v[140:143], a[220:223], v[16:19], 0
  v_mfma_f32_16x16x32_bf16 v[144:147], a[240:243], v[16:19], 0
  s_waitcnt vmcnt(11)
  v_mfma_f32_16x16x32_bf16 v[148:151], a[160:163], v[20:23], 0
  v_lshlrev_b32 v180, 16, v230
  v_mfma_f32_16x16x32_bf16 v[152:155], a[180:183], v[20:23], 0
  s_add_u32 s55, s69, 4096
  buffer_load_dwordx4 v[84:87], v2, s[28:31], s55 offen sc1
  v_and_b32 v181, 0xffff0000, v230
  v_mfma_f32_16x16x32_bf16 v[156:159], a[200:203], v[20:23], 0
  v_lshlrev_b32 v182, 16, v231
  v_mfma_f32_16x16x32_bf16 v[160:163], a[220:223], v[20:23], 0
  v_and_b32 v183, 0xffff0000, v231
  v_mfma_f32_16x16x32_bf16 v[164:167], a[240:243], v[20:23], 0
  v_lshlrev_b32 v184, 16, v232
  s_waitcnt vmcnt(11)
  v_mfma_f32_16x16x32_bf16 v[108:111], a[164:167], v[28:31], v[108:111]
  v_and_b32 v185, 0xffff0000, v232
  v_mfma_f32_16x16x32_bf16 v[112:115], a[184:187], v[28:31], v[112:115]
  buffer_load_dwordx4 v[8:11], v2, s[28:31], s66 offen offset:0 sc1
  v_lshlrev_b32 v186, 16, v233
  v_mfma_f32_16x16x32_bf16 v[116:119], a[204:207], v[28:31], v[116:119]
  v_and_b32 v187, 0xffff0000, v233
  v_mfma_f32_16x16x32_bf16 v[120:123], a[224:227], v[28:31], v[120:123]
  v_lshlrev_b32 v188, 16, v234
  v_mfma_f32_16x16x32_bf16 v[124:127], a[244:247], v[28:31], v[124:127]
  v_and_b32 v189, 0xffff0000, v234
  s_waitcnt vmcnt(11)
  v_mfma_f32_16x16x32_bf16 v[128:131], a[164:167], v[32:35], v[128:131]
  v_lshlrev_b32 v190, 16, v235
  v_mfma_f32_16x16x32_bf16 v[132:135], a[184:187], v[32:35], v[132:135]
  buffer_load_dwordx4 v[24:27], v2, s[28:31], s66 offen offset:1024 sc1
  v_and_b32 v191, 0xffff0000, v235
  v_mfma_f32_16x16x32_bf16 v[136:139], a[204:207], v[32:35], v[136:139]
  v_lshlrev_b32 v192, 16, v236
  v_mfma_f32_16x16x32_bf16 v[140:143], a[224:227], v[32:35], v[140:143]
  v_and_b32 v193, 0xffff0000, v236
  v_mfma_f32_16x16x32_bf16 v[144:147], a[244:247], v[32:35], v[144:147]
  v_lshlrev_b32 v194, 16, v237
  s_waitcnt vmcnt(11)
  v_mfma_f32_16x16x32_bf16 v[148:151], a[164:167], v[36:39], v[148:151]
  v_and_b32 v195, 0xffff0000, v237
  v_mfma_f32_16x16x32_bf16 v[152:155], a[184:187], v[36:39], v[152:155]
  buffer_load_dwordx4 v[40:43], v2, s[28:31], s66 offen offset:2048 sc1
  v_lshlrev_b32 v196, 16, v238
  v_mfma_f32_16x16x32_bf16 v[156:159], a[204:207], v[36:39], v[156:159]
  v_and_b32 v197, 0xffff0000, v238
  v_mfma_f32_16x16x32_bf16 v[160:163], a[224:227], v[36:39], v[160:163]
  v_lshlrev_b32 v198, 16, v239
  v_mfma_f32_16x16x32_bf16 v[164:167], a[244:247], v[36:39], v[164:167]
  v_and_b32 v199, 0xffff0000, v239
  s_waitcnt vmcnt(11)
  v_mfma_f32_16x16x32_bf16 v[108:111], a[168:171], v[44:47], v[108:111]
  v_mfma_f32_16x16x32_bf16 v[112:115], a[188:191], v[44:47], v[112:115]
  buffer_load_dwordx4 v[56:59], v2, s[28:31], s66 offen offset:3072 sc1
  v_mfma_f32_16x16x32_bf16 v[116:119], a[208:211], v[44:47], v[116:119]
  v_mfma_f32_16x16x32_bf16 v[120:123], a[228:231], v[44:47], v[120:123]
  v_mfma_f32_16x16x32_bf16 v[124:127], a[248:251], v[44:47], v[124:127]
  s_waitcnt vmcnt(11)
  v_mfma_f32_16x16x32_bf16 v[128:131], a[168:171], v[48:51], v[128:131]
  v_mfma_f32_16x16x32_bf16 v[132:135], a[188:191], v[48:51], v[132:135]
  s_add_u32 s55, s66, 4096
  buffer_load_dwordx4 v[72:75], v2, s[28:31], s55 offen sc1
  v_mfma_f32_16x16x32_bf16 v[136:139], a[208:211], v[48:51], v[136:139]
  v_mfma_f32_16x16x32_bf16 v[140:143], a[228:231], v[48:51], v[140:143]
  v_mfma_f32_16x16x32_bf16 v[144:147], a[248:251], v[48:51], v[144:147]
  s_waitcnt vmcnt(11)
  v_mfma_f32_16x16x32_bf16 v[148:151], a[168:171], v[52:55], v[148:151]
  v_mfma_f32_16x16x32_bf16 v[152:155], a[188:191], v[52:55], v[152:155]
  v_mfma_f32_16x16x32_bf16 v[156:159], a[208:211], v[52:55], v[156:159]
  v_mfma_f32_16x16x32_bf16 v[160:163], a[228:231], v[52:55], v[160:163]
  v_mfma_f32_16x16x32_bf16 v[164:167], a[248:251], v[52:55], v[164:167]
  s_waitcnt vmcnt(10)
  v_mfma_f32_16x16x32_bf16 v[108:111], a[172:175], v[60:63], v[108:111]
  v_mfma_f32_16x16x32_bf16 v[112:115], a[192:195], v[60:63], v[112:115]
  v_mfma_f32_16x16x32_bf16 v[116:119], a[212:215], v[60:63], v[116:119]
  v_mfma_f32_16x16x32_bf16 v[120:123], a[232:235], v[60:63], v[120:123]
  v_mfma_f32_16x16x32_bf16 v[124:127], a[252:255], v[60:63], v[124:127]
  s_waitcnt vmcnt(9)
  v_mfma_f32_16x16x32_bf16 v[128:131], a[172:175], v[64:67], v[128:131]
  v_mfma_f32_16x16x32_bf16 v[132:135], a[192:195], v[64:67], v[132:135]
  v_mfma_f32_16x16x32_bf16 v[136:139], a[212:215], v[64:67], v[136:139]
  v_mfma_f32_16x16x32_bf16 v[140:143], a[232:235], v[64:67], v[140:143]
  v_mfma_f32_16x16x32_bf16 v[144:147], a[252:255], v[64:67], v[144:147]
  s_waitcnt vmcnt(8)
  v_mfma_f32_16x16x32_bf16 v[148:151], a[172:175], v[68:71], v[148:151]
  v_mfma_f32_16x16x32_bf16 v[152:155], a[192:195], v[68:71], v[152:155]
  v_mfma_f32_16x16x32_bf16 v[156:159], a[212:215], v[68:71], v[156:159]
  v_mfma_f32_16x16x32_bf16 v[160:163], a[232:235], v[68:71], v[160:163]
  v_mfma_f32_16x16x32_bf16 v[164:167], a[252:255], v[68:71], v[164:167]
  s_waitcnt vmcnt(7)
  v_mfma_f32_16x16x32_bf16 v[108:111], a[176:179], v[76:79], v[108:111]
  v_mfma_f32_16x16x32_bf16 v[112:115], a[196:199], v[76:79], v[112:115]
  v_mfma_f32_16x16x32_bf16 v[116:119], a[216:219], v[76:79], v[116:119]
  v_mfma_f32_16x16x32_bf16 v[120:123], a[236:239], v[76:79], v[120:123]
  v_mfma_f32_16x16x32_bf16 v[124:127], v[240:243], v[76:79], v[124:127]
  s_waitcnt vmcnt(6)
  v_mfma_f32_16x16x32_bf16 v[128:131], a[176:179], v[80:83], v[128:131]
  v_mfma_f32_16x16x32_bf16 v[132:135], a[196:199], v[80:83], v[132:135]
  v_mfma_f32_16x16x32_bf16 v[136:139], a[216:219], v[80:83], v[136:139]
  v_mfma_f32_16x16x32_bf16 v[140:143], a[236:239], v[80:83], v[140:143]
  v_mfma_f32_16x16x32_bf16 v[144:147], v[240:243], v[80:83], v[144:147]
  s_waitcnt vmcnt(5)
  v_mfma_f32_16x16x32_bf16 v[148:151], a[176:179], v[84:87], v[148:151]
  v_mfma_f32_16x16x32_bf16 v[152:155], a[196:199], v[84:87], v[152:155]
  v_mfma_f32_16x16x32_bf16 v[156:159], a[216:219], v[84:87], v[156:159]
  v_mfma_f32_16x16x32_bf16 v[160:163], a[236:239], v[84:87], v[160:163]
  v_mfma_f32_16x16x32_bf16 v[164:167], v[240:243], v[84:87], v[164:167]
  s_waitcnt vmcnt(4)
  v_mfma_f32_16x16x32_bf16 v[88:91], a[160:163], v[8:11], 0
  v_mfma_f32_16x16x32_bf16 v[92:95], a[180:183], v[8:11], 0
  v_mfma_f32_16x16x32_bf16 v[96:99], a[200:203], v[8:11], 0
  ds_write_b128 v169, v[108:111] offset:0
  v_mfma_f32_16x16x32_bf16 v[100:103], a[220:223], v[8:11], 0
  v_mfma_f32_16x16x32_bf16 v[104:107], a[240:243], v[8:11], 0
  ds_write_b128 v169, v[112:115] offset:1024
  s_waitcnt vmcnt(3)
  v_mfma_f32_16x16x32_bf16 v[88:91], a[164:167], v[24:27], v[88:91]
  ds_write_b128 v169, v[116:119] offset:2048
  v_mfma_f32_16x16x32_bf16 v[92:95], a[184:187], v[24:27], v[92:95]
  v_mfma_f32_16x16x32_bf16 v[96:99], a[204:207], v[24:27], v[96:99]
  ds_write_b128 v169, v[120:123] offset:3072
  v_mfma_f32_16x16x32_bf16 v[100:103], a[224:227], v[24:27], v[100:103]
  ds_write_b128 v169, v[124:127] offset:4096
  v_mfma_f32_16x16x32_bf16 v[104:107], a[244:247], v[24:27], v[104:107]
  s_waitcnt vmcnt(2)
  v_mfma_f32_16x16x32_bf16 v[88:91], a[168:171], v[40:43], v[88:91]
  ds_write_b128 v170, v[128:131] offset:0
  v_mfma_f32_16x16x32_bf16 v[92:95], a[188:191], v[40:43], v[92:95]
  ds_write_b128 v170, v[132:135] offset:1024
  v_mfma_f32_16x16x32_bf16 v[96:99], a[208:211], v[40:43], v[96:99]
  v_mfma_f32_16x16x32_bf16 v[100:103], a[228:231], v[40:43], v[100:103]
  ds_write_b128 v170, v[136:139] offset:2048
  v_mfma_f32_16x16x32_bf16 v[104:107], a[248:251], v[40:43], v[104:107]
  ds_write_b128 v170, v[140:143] offset:3072
  s_waitcnt vmcnt(1)
  v_mfma_f32_16x16x32_bf16 v[88:91], a[172:175], v[56:59], v[88:91]
  v_mfma_f32_16x16x32_bf16 v[92:95], a[192:195], v[56:59], v[92:95]
  ds_write_b128 v170, v[144:147] offset:4096
  v_mfma_f32_16x16x32_bf16 v[96:99], a[212:215], v[56:59], v[96:99]
  ds_write_b128 v171, v[148:151] offset:0
  v_mfma_f32_16x16x32_bf16 v[100:103], a[232:235], v[56:59], v[100:103]
  v_mfma_f32_16x16x32_bf16 v[104:107], a[252:255], v[56:59], v[104:107]
  ds_write_b128 v171, v[152:155] offset:1024
  s_waitcnt vmcnt(0)
  v_mfma_f32_16x16x32_bf16 v[88:91], a[176:179], v[72:75], v[88:91]
  ds_write_b128 v171, v[156:159] offset:2048
  v_mfma_f32_16x16x32_bf16 v[92:95], a[196:199], v[72:75], v[92:95]
  v_mfma_f32_16x16x32_bf16 v[96:99], a[216:219], v[72:75], v[96:99]
  ds_write_b128 v171, v[160:163] offset:3072
  v_mfma_f32_16x16x32_bf16 v[100:103], a[236:239], v[72:75], v[100:103]
  ds_write_b128 v171, v[164:167] offset:4096
  v_mfma_f32_16x16x32_bf16 v[104:107], v[240:243], v[72:75], v[104:107]
  s_add_u32 s99, s93, 169984
  buffer_load_dwordx4 a[112:115], v2, s[28:31], s99 offen offset:1024 sc1
  s_add_u32 s99, s93, 225280
  buffer_load_dwordx4 a[96:99], v2, s[28:31], s99 offen offset:0 sc1
  s_add_u32 s99, s93, 225280
  buffer_load_dwordx4 a[116:119], v2, s[28:31], s99 offen offset:1024 sc1
  s_add_u32 s99, s93, 4096
  buffer_load_dwordx4 a[120:123], v2, s[28:31], s99 offen offset:2048 sc1
  s_add_u32 s99, s93, 4096
  buffer_load_dwordx4 a[140:143], v2, s[28:31], s99 offen offset:3072 sc1
  s_add_u32 s99, s93, 59392
  buffer_load_dwordx4 a[124:127], v2, s[28:31], s99 offen offset:2048 sc1
  s_add_u32 s99, s93, 59392
  buffer_load_dwordx4 a[144:147], v2, s[28:31], s99 offen offset:3072 sc1
  s_add_u32 s99, s93, 114688
  buffer_load_dwordx4 a[128:131], v2, s[28:31], s99 offen offset:2048 sc1
  s_add_u32 s99, s93, 114688
  buffer_load_dwordx4 a[148:151], v2, s[28:31], s99 offen offset:3072 sc1
  s_add_u32 s99, s93, 169984
  buffer_load_dwordx4 a[132:135], v2, s[28:31], s99 offen offset:2048 sc1
  v_pk_add_f32 v[88:89], v[88:89], v[180:181]
  v_pk_add_f32 v[90:91], v[90:91], v[182:183]
  v_pk_add_f32 v[92:93], v[92:93], v[184:185]
  v_pk_add_f32 v[94:95], v[94:95], v[186:187]
  v_pk_add_f32 v[96:97], v[96:97], v[188:189]
  v_pk_add_f32 v[98:99], v[98:99], v[190:191]
  v_pk_add_f32 v[100:101], v[100:101], v[192:193]
  v_pk_add_f32 v[102:103], v[102:103], v[194:195]
  v_pk_add_f32 v[104:105], v[104:105], v[196:197]
  v_pk_add_f32 v[106:107], v[106:107], v[198:199]
  s_waitcnt lgkmcnt(0)
  s_barrier
  ds_read_b128 v[8:11], v168 offset:0
  ds_read_b128 v[12:15], v168 offset:1024
  ds_read_b128 v[16:19], v168 offset:2048
  ds_read_b128 v[20:23], v168 offset:3072
  ds_read_b128 v[24:27], v168 offset:4096
  ds_read_b128 v[28:31], v168 offset:5120
  ds_read_b128 v[32:35], v168 offset:6144
  ds_read_b128 v[36:39], v168 offset:7168
  ds_read_b128 v[40:43], v168 offset:8192
  ds_read_b128 v[44:47], v168 offset:9216
  ds_read_b128 v[48:51], v168 offset:10240
  ds_read_b128 v[52:55], v168 offset:11264
  ds_read_b128 v[56:59], v168 offset:12288
  ds_read_b128 v[60:63], v168 offset:13312
  ds_read_b128 v[64:67], v168 offset:14336
  s_waitcnt lgkmcnt(14)
  v_pk_add_f32 v[88:89], v[88:89], v[8:9]
  v_pk_add_f32 v[90:91], v[90:91], v[10:11]
  s_waitcnt lgkmcnt(13)
  v_pk_add_f32 v[92:93], v[92:93], v[12:13]
  v_pk_add_f32 v[94:95], v[94:95], v[14:15]
  s_waitcnt lgkmcnt(12)
  v_pk_add_f32 v[96:97], v[96:97], v[16:17]
  v_pk_add_f32 v[98:99], v[98:99], v[18:19]
  s_waitcnt lgkmcnt(11)
  v_pk_add_f32 v[100:101], v[100:101], v[20:21]
  v_pk_add_f32 v[102:103], v[102:103], v[22:23]
  s_waitcnt lgkmcnt(10)
  v_pk_add_f32 v[104:105], v[104:105], v[24:25]
  v_pk_add_f32 v[106:107], v[106:107], v[26:27]
  s_waitcnt lgkmcnt(9)
  v_pk_add_f32 v[88:89], v[88:89], v[28:29]
  v_pk_add_f32 v[90:91], v[90:91], v[30:31]
  s_waitcnt lgkmcnt(8)
  v_pk_add_f32 v[92:93], v[92:93], v[32:33]
  v_pk_add_f32 v[94:95], v[94:95], v[34:35]
  s_waitcnt lgkmcnt(7)
  v_pk_add_f32 v[96:97], v[96:97], v[36:37]
  v_pk_add_f32 v[98:99], v[98:99], v[38:39]
  s_waitcnt lgkmcnt(6)
  v_pk_add_f32 v[100:101], v[100:101], v[40:41]
  v_pk_add_f32 v[102:103], v[102:103], v[42:43]
  s_waitcnt lgkmcnt(5)
  v_pk_add_f32 v[104:105], v[104:105], v[44:45]
  v_pk_add_f32 v[106:107], v[106:107], v[46:47]
  s_waitcnt lgkmcnt(4)
  v_pk_add_f32 v[88:89], v[88:89], v[48:49]
  v_pk_add_f32 v[90:91], v[90:91], v[50:51]
  s_waitcnt lgkmcnt(3)
  v_pk_add_f32 v[92:93], v[92:93], v[52:53]
  v_pk_add_f32 v[94:95], v[94:95], v[54:55]
  s_waitcnt lgkmcnt(2)
  v_pk_add_f32 v[96:97], v[96:97], v[56:57]
  v_pk_add_f32 v[98:99], v[98:99], v[58:59]
  s_waitcnt lgkmcnt(1)
  v_pk_add_f32 v[100:101], v[100:101], v[60:61]
  v_pk_add_f32 v[102:103], v[102:103], v[62:63]
  s_waitcnt lgkmcnt(0)
  v_pk_add_f32 v[104:105], v[104:105], v[64:65]
  v_pk_add_f32 v[106:107], v[106:107], v[66:67]
  v_cvt_pk_bf16_f32 v246, v88, v89
  v_cvt_pk_bf16_f32 v247, v90, v91
  v_cvt_pk_bf16_f32 v248, v92, v93
  v_cvt_pk_bf16_f32 v249, v94, v95
  v_cvt_pk_bf16_f32 v250, v96, v97
  v_cvt_pk_bf16_f32 v251, v98, v99
  v_cvt_pk_bf16_f32 v252, v100, v101
  v_cvt_pk_bf16_f32 v253, v102, v103
  v_cvt_pk_bf16_f32 v254, v104, v105
  v_cvt_pk_bf16_f32 v255, v106, v107
  s_bitcmp1_b32 s62, 0
  s_cbranch_scc1 L_odd_22
  buffer_store_dwordx4 v[246:249], v2, s[28:31], s60 offen offset:0 sc1
  buffer_store_dwordx4 v[250:253], v2, s[28:31], s60 offen offset:1024 sc1
  v_mov_b32 v72, v254
  v_mov_b32 v73, v255
  v_mov_b32 v74, v254
  v_mov_b32 v75, v255
  s_nop 0
  v_permlane16_swap_b32 v72, v74
  v_permlane16_swap_b32 v73, v75
  s_mov_b32 exec_lo, 0xffff
  s_mov_b32 exec_hi, 0xffff
  buffer_store_dwordx4 v[72:75], v173, s[28:31], s60 offen offset:2048 sc1
  s_mov_b64 exec, -1
  s_branch L_se_23
L_odd_22:
  s_add_u32 s56, s60, 4096
  buffer_store_dwordx4 v[248:251], v2, s[28:31], s60 offen offset:3072 sc1
  buffer_store_dwordx4 v[252:255], v2, s[28:31], s56 offen sc1
  v_mov_b32 v72, v246
  v_mov_b32 v73, v247
  v_mov_b32 v74, v246
  v_mov_b32 v75, v247
  s_nop 0
  v_permlane16_swap_b32 v72, v74
  v_permlane16_swap_b32 v73, v75
  s_mov_b32 exec_lo, 0xffff
  s_mov_b32 exec_hi, 0xffff
  buffer_store_dwordx4 v[72:75], v173, s[28:31], s60 offen offset:2560 sc1
  s_mov_b64 exec, -1
L_se_23:
  v_pk_add_f32 v[8:9], v[88:89], v[90:91]
  v_pk_mul_f32 v[10:11], v[88:89], v[88:89]
  v_pk_fma_f32 v[10:11], v[90:91], v[90:91], v[10:11]
  v_pk_add_f32 v[8:9], v[8:9], v[92:93]
  v_pk_fma_f32 v[10:11], v[92:93], v[92:93], v[10:11]
  v_pk_add_f32 v[8:9], v[8:9], v[94:95]
  v_pk_fma_f32 v[10:11], v[94:95], v[94:95], v[10:11]
  v_pk_add_f32 v[8:9], v[8:9], v[96:97]
  v_pk_fma_f32 v[10:11], v[96:97], v[96:97], v[10:11]
  v_pk_add_f32 v[8:9], v[8:9], v[98:99]
  v_pk_fma_f32 v[10:11], v[98:99], v[98:99], v[10:11]
  v_pk_add_f32 v[8:9], v[8:9], v[100:101]
  v_pk_fma_f32 v[10:11], v[100:101], v[100:101], v[10:11]
  v_pk_add_f32 v[8:9], v[8:9], v[102:103]
  v_pk_fma_f32 v[10:11], v[102:103], v[102:103], v[10:11]
  v_pk_add_f32 v[8:9], v[8:9], v[104:105]
  v_pk_fma_f32 v[10:11], v[104:105], v[104:105], v[10:11]
  v_pk_add_f32 v[8:9], v[8:9], v[106:107]
  v_pk_fma_f32 v[10:11], v[106:107], v[106:107], v[10:11]
  v_add_f32 v8, v8, v9
  v_add_f32 v9, v10, v11
  v_mov_b32 v10, v8
  v_mov_b32 v11, v9
  s_nop 0
  v_permlane16_swap_b32 v8, v10
  v_permlane16_swap_b32 v9, v11
  v_add_f32 v8, v8, v10
  v_add_f32 v9, v9, v11
  v_mov_b32 v10, v8
  v_mov_b32 v11, v9
  s_nop 0
  v_permlane32_swap_b32 v8, v10
  v_permlane32_swap_b32 v9, v11
  v_add_f32 v8, v8, v10
  v_add_f32 v9, v9, v11
  s_mov_b64 exec, 0xffff
  buffer_store_dwordx2 v[8:9], v172, s[28:31], s61 offen sc1
  s_mov_b64 exec, -1
  s_lshl_b32 s64, s49, 3
  s_lshl_b32 s55, s48, 1
  s_add_u32 s64, s64, s55
  s_mul_i32 s60, s64, 20480
  s_add_u32 s60, s60, 9256960
  s_add_u32 s61, s60, 20480
  s_lshl_b32 s62, s64, 10
  s_add_u32 s62, s62, 23920640
  v_and_b32 v5, 15, v1
  v_lshrrev_b32 v12, 4, v1
  v_lshlrev_b32 v5, 3, v5
  v_lshl_add_u32 v5, v12, 8, v5
  s_mul_i32 s66, s64, 55296
  s_lshr_b32 s55, s50, 1
  s_mul_i32 s55, s55, 7168
  s_add_u32 s66, s66, s55
  s_add_u32 s66, s66, 11878400
  s_add_u32 s67, s66, 55296
  s_add_u32 s68, s66, 4096
  s_add_u32 s69, s67, 4096
  s_lshl_b32 s58, s49, 7
  s_add_u32 s58, s58, 24326144
  s_lshl_b32 s59, s50, 2
  v_mov_b32 v6, s59
  v_mov_b32 v7, s51
  s_cmp_lg_u32 s48, 0
  s_waitcnt vmcnt(0)
  s_barrier
  s_cbranch_scc1 L_sig_24
  s_mov_b64 exec, 1
  buffer_store_dword v7, v6, s[28:31], s58 offen sc1
  s_mov_b64 exec, -1
L_sig_24:
  v_lshrrev_b32 v9, 5, v1
  v_and_b32 v10, 31, v1
  v_min_u32 v10, 27, v10
  v_mul_u32_u24 v9, 6912, v9
  v_lshl_add_u32 v9, v10, 4, v9
  s_mul_i32 s70, s50, 448
  s_mul_i32 s55, s48, 27648
  s_add_u32 s70, s70, s55
  s_add_u32 s70, s70, 24182784
  s_add_u32 s71, s70, 13824
  buffer_load_dwordx4 v[12:15], v9, s[28:31], s70 offen sc1
  buffer_load_dwordx4 v[16:19], v9, s[28:31], s71 offen sc1
  s_mov_b32 m0, s89
  s_nop 0
  buffer_load_dwordx4 v2, s[44:47], s89 offen sc1 lds
  s_add_u32 s89, s89, 4096
  s_mov_b32 m0, s89
  s_nop 0
  buffer_load_dwordx4 v2, s[44:47], s89 offen sc1 lds
  s_add_u32 s89, s89, 4096
  s_mov_b32 m0, s89
  s_nop 0
  buffer_load_dwordx4 v2, s[44:47], s89 offen sc1 lds
  s_add_u32 s89, s89, 4096
  s_mov_b32 m0, s89
  s_nop 0
  buffer_load_dwordx4 v2, s[44:47], s89 offen sc1 lds
  s_add_u32 s89, s89, 4096
  s_mov_b32 m0, s89
  s_nop 0
  buffer_load_dwordx4 v2, s[44:47], s89 offen sc1 lds
  s_add_u32 s89, s89, 4096
  s_mov_b32 m0, s89
  s_nop 0
  buffer_load_dwordx4 v2, s[44:47], s89 offen sc1 lds
  s_add_u32 s89, s89, 4096
  s_mov_b32 m0, s89
  s_nop 0
  buffer_load_dwordx4 v2, s[44:47], s89 offen sc1 lds
  s_add_u32 s89, s89, 4096
  s_mov_b32 m0, s89
  s_nop 0
  buffer_load_dwordx4 v2, s[44:47], s89 offen sc1 lds
  s_add_u32 s89, s89, 4096
  s_mov_b32 m0, s89
  s_nop 0
  buffer_load_dwordx4 v2, s[44:47], s89 offen sc1 lds
  s_add_u32 s89, s89, 4096
  s_mov_b32 m0, s89
  s_nop 0
  buffer_load_dwordx4 v2, s[44:47], s89 offen sc1 lds
  s_add_u32 s89, s89, 4096
  s_lshl_b32 s55, s48, 9
  s_add_u32 s55, s55, 161792
  v_lshlrev_b32 v10, 4, v10
  v_add_u32 v10, s55, v10
  v_and_b32 v11, 15, v1
  v_lshlrev_b32 v11, 2, v11
  v_add_u32 v241, 161792, v11
  s_waitcnt vmcnt(10)
  v_pk_add_f32 v[12:13], v[12:13], v[16:17]
  v_pk_add_f32 v[14:15], v[14:15], v[18:19]
  v_mov_b32 v16, v12
  v_mov_b32 v17, v13
  v_mov_b32 v18, v14
  v_mov_b32 v19, v15
  v_permlane32_swap_b32 v12, v16
  v_permlane32_swap_b32 v13, v17
  v_permlane32_swap_b32 v14, v18
  v_permlane32_swap_b32 v15, v19
  v_pk_add_f32 v[12:13], v[12:13], v[16:17]
  v_pk_add_f32 v[14:15], v[14:15], v[18:19]
  ds_write_b128 v10, v[12:15]
  s_waitcnt lgkmcnt(0)
  s_cmp_lg_u32 s48, 0
  s_cbranch_scc1 L_wt_25
  s_lshl_b32 s58, s49, 7
  s_add_u32 s58, s58, 24326144
  v_lshlrev_b32 v6, 2, v1
  s_mov_b64 exec, 0xffff
  s_mov_b32 s57, 0
L_poll_26:
  buffer_load_dword v7, v6, s[28:31], s58 offen sc1
  s_add_u32 s57, s57, 1
  s_waitcnt vmcnt(0)
  v_cmp_ne_u32 vcc, s51, v7
  s_cmp_ge_u32 s57, 32768
  s_cbranch_scc1 L_pd_27
  s_cbranch_vccnz L_poll_26
L_pd_27:
  s_mov_b64 exec, -1
L_wt_25:
  s_barrier
  buffer_load_dwordx4 v[8:11], v2, s[28:31], s60 offen offset:0 sc1
  buffer_load_dwordx4 v[12:15], v2, s[28:31], s61 offen offset:0 sc1
  buffer_load_dwordx2 v[224:225], v5, s[28:31], s62 offen offset:0 sc1
  buffer_load_dwordx2 v[226:227], v5, s[28:31], s62 offen offset:128 sc1
  buffer_load_dwordx2 v[228:229], v5, s[28:31], s62 offen offset:1024 sc1
  buffer_load_dwordx2 v[230:231], v5, s[28:31], s62 offen offset:1152 sc1
  buffer_load_dwordx4 v[16:19], v2, s[28:31], s60 offen offset:1024 sc1
  buffer_load_dwordx4 v[20:23], v2, s[28:31], s61 offen offset:1024 sc1
  buffer_load_dwordx4 v[24:27], v2, s[28:31], s60 offen offset:2048 sc1
  buffer_load_dwordx4 v[28:31], v2, s[28:31], s61 offen offset:2048 sc1
  buffer_load_dwordx4 v[32:35], v2, s[28:31], s60 offen offset:3072 sc1
  buffer_load_dwordx4 v[36:39], v2, s[28:31], s61 offen offset:3072 sc1
  s_add_u32 s60, s60, 4096
  s_add_u32 s61, s61, 4096
  buffer_load_dwordx4 v[40:43], v2, s[28:31], s60 offen offset:0 sc1
  buffer_load_dwordx4 v[44:47], v2, s[28:31], s61 offen offset:0 sc1
  ds_read_b128 a[196:199], v2 offset:0
  ds_read_b128 a[200:203], v2 offset:20480
  ds_read_b128 a[204:207], v2 offset:40960
  ds_read_b128 a[208:211], v2 offset:61440
  ds_read_b128 a[212:215], v3 offset:16384
  ds_read_b128 a[216:219], v2 offset:1024
  s_waitcnt vmcnt(12)
  s_waitcnt lgkmcnt(4)
  v_mfma_f32_16x16x32_bf16 v[168:171], a[196:199], v[8:11], 0
  ds_read_b128 a[220:223], v2 offset:21504
  v_mfma_f32_16x16x32_bf16 v[196:199], a[196:199], v[12:15], 0
  v_mfma_f32_16x16x32_bf16 v[172:175], a[200:203], v[8:11], 0
  ds_read_b128 a[224:227], v2 offset:41984
  v_mfma_f32_16x16x32_bf16 v[200:203], a[200:203], v[12:15], 0
  buffer_load_dwordx4 v[48:51], v2, s[28:31], s60 offen offset:1024 sc1
  buffer_load_dwordx4 v[52:55], v2, s[28:31], s61 offen offset:1024 sc1
  s_waitcnt lgkmcnt(4)
  v_mfma_f32_16x16x32_bf16 v[176:179], a[204:207], v[8:11], 0
  ds_read_b128 a[196:199], v2 offset:62464
  v_mfma_f32_16x16x32_bf16 v[204:207], a[204:207], v[12:15], 0
  ds_read_b32 v240, v241 offset:0
  ds_read_b32 v242, v241 offset:512
  ds_read_b32 v243, v241 offset:1024
  ds_read_b32 v6, v241 offset:1536
  v_mfma_f32_16x16x32_bf16 v[180:183], a[208:211], v[8:11], 0
  ds_read_b128 a[200:203], v3 offset:17408
  v_mfma_f32_16x16x32_bf16 v[208:211], a[208:211], v[12:15], 0
  s_waitcnt lgkmcnt(4)
  v_mfma_f32_16x16x32_bf16 v[184:187], a[212:215], v[8:11], 0
  ds_read_b128 a[204:207], v2 offset:2048
  v_mfma_f32_16x16x32_bf16 v[212:215], a[212:215], v[12:15], 0
  s_waitcnt vmcnt(8)
  v_mfma_f32_16x16x32_bf16 v[168:171], a[216:219], v[16:19], v[168:171]
  ds_read_b128 a[208:211], v2 offset:22528
  v_mfma_f32_16x16x32_bf16 v[196:199], a[216:219], v[20:23], v[196:199]
  s_waitcnt lgkmcnt(4)
  v_mfma_f32_16x16x32_bf16 v[172:175], a[220:223], v[16:19], v[172:175]
  ds_read_b128 a[212:215], v2 offset:43008
  v_mfma_f32_16x16x32_bf16 v[200:203], a[220:223], v[20:23], v[200:203]
  buffer_load_dwordx4 v[56:59], v2, s[28:31], s60 offen offset:2048 sc1
  buffer_load_dwordx4 v[60:63], v2, s[28:31], s61 offen offset:2048 sc1
  v_mfma_f32_16x16x32_bf16 v[176:179], a[224:227], v[16:19], v[176:179]
  ds_read_b128 a[216:219], v2 offset:63488
  v_mfma_f32_16x16x32_bf16 v[204:207], a[224:227], v[20:23], v[204:207]
  s_waitcnt lgkmcnt(4)
  v_mfma_f32_16x16x32_bf16 v[180:183], a[196:199], v[16:19], v[180:183]
  ds_read_b128 a[220:223], v3 offset:18432
  v_mfma_f32_16x16x32_bf16 v[208:211], a[196:199], v[20:23], v[208:211]
  v_mfma_f32_16x16x32_bf16 v[184:187], a[200:203], v[16:19], v[184:187]
  ds_read_b128 a[224:227], v2 offset:3072
  v_mfma_f32_16x16x32_bf16 v[212:215], a[200:203], v[20:23], v[212:215]
  v_add_f32 v240, v240, v242
  s_waitcnt vmcnt(8)
  s_waitcnt lgkmcnt(4)
  v_mfma_f32_16x16x32_bf16 v[168:171], a[204:207], v[24:27], v[168:171]
  ds_read_b128 a[196:199], v2 offset:23552
  v_mfma_f32_16x16x32_bf16 v[196:199], a[204:207], v[28:31], v[196:199]
  v_add_f32 v243, v243, v6
  v_mfma_f32_16x16x32_bf16 v[172:175], a[208:211], v[24:27], v[172:175]
  ds_read_b128 a[200:203], v2 offset:44032
  v_mfma_f32_16x16x32_bf16 v[200:203], a[208:211], v[28:31], v[200:203]
  v_add_f32 v240, v240, v243
  buffer_load_dwordx4 v[64:67], v2, s[28:31], s60 offen offset:3072 sc1
  buffer_load_dwordx4 v[68:71], v2, s[28:31], s61 offen offset:3072 sc1
  s_add_u32 s60, s60, 4096
  s_add_u32 s61, s61, 4096
  s_waitcnt lgkmcnt(4)
  v_mfma_f32_16x16x32_bf16 v[176:179], a[212:215], v[24:27], v[176:179]
  ds_read_b128 a[204:207], v2 offset:64512
  v_mfma_f32_16x16x32_bf16 v[204:207], a[212:215], v[28:31], v[204:207]
  v_cvt_pk_bf16_f32 v242, v240, 0
  v_mfma_f32_16x16x32_bf16 v[180:183], a[216:219], v[24:27], v[180:183]
  ds_read_b128 a[208:211], v3 offset:19456
  v_mfma_f32_16x16x32_bf16 v[208:211], a[216:219], v[28:31], v[208:211]
  v_lshlrev_b32 v243, 16, v242
  s_waitcnt lgkmcnt(4)
  v_mfma_f32_16x16x32_bf16 v[184:187], a[220:223], v[24:27], v[184:187]
  ds_read_b128 a[212:215], v2 offset:4096
  v_mfma_f32_16x16x32_bf16 v[212:215], a[220:223], v[28:31], v[212:215]
  v_accvgpr_write_b32 a229, v242
  v_sub_f32 v243, v240, v243
  s_waitcnt vmcnt(8)
  v_mfma_f32_16x16x32_bf16 v[168:171], a[224:227], v[32:35], v[168:171]
  ds_read_b128 a[216:219], v2 offset:24576
  v_mfma_f32_16x16x32_bf16 v[196:199], a[224:227], v[36:39], v[196:199]
  v_cvt_pk_bf16_f32 v240, v240, v243
  v_accvgpr_write_b32 a230, 0
  s_waitcnt lgkmcnt(4)
  v_mfma_f32_16x16x32_bf16 v[172:175], a[196:199], v[32:35], v[172:175]
  ds_read_b128 a[220:223], v2 offset:45056
  v_mfma_f32_16x16x32_bf16 v[200:203], a[196:199], v[36:39], v[200:203]
  v_accvgpr_write_b32 a228, v240
  v_accvgpr_write_b32 a231, 0
  buffer_load_dwordx4 v[72:75], v2, s[28:31], s60 offen offset:0 sc1
  buffer_load_dwordx4 v[76:79], v2, s[28:31], s61 offen offset:0 sc1
  v_mfma_f32_16x16x32_bf16 v[176:179], a[200:203], v[32:35], v[176:179]
  ds_read_b128 a[224:227], v3 offset:0
  v_mfma_f32_16x16x32_bf16 v[204:207], a[200:203], v[36:39], v[204:207]
  ds_read_b32 v240, v241 offset:64
  ds_read_b32 v242, v241 offset:576
  ds_read_b32 v243, v241 offset:1088
  ds_read_b32 v6, v241 offset:1600
  s_waitcnt lgkmcnt(4)
  v_mfma_f32_16x16x32_bf16 v[180:183], a[204:207], v[32:35], v[180:183]
  ds_read_b128 a[196:199], v3 offset:20480
  v_mfma_f32_16x16x32_bf16 v[208:211], a[204:207], v[36:39], v[208:211]
  v_mfma_f32_16x16x32_bf16 v[184:187], a[208:211], v[32:35], v[184:187]
  ds_read_b128 a[200:203], v2 offset:5120
  v_mfma_f32_16x16x32_bf16 v[212:215], a[208:211], v[36:39], v[212:215]
  s_waitcnt vmcnt(8)
  s_waitcnt lgkmcnt(4)
  v_mfma_f32_16x16x32_bf16 v[168:171], a[212:215], v[40:43], v[168:171]
  ds_read_b128 a[204:207], v2 offset:25600
  v_mfma_f32_16x16x32_bf16 v[196:199], a[212:215], v[44:47], v[196:199]
  s_waitcnt vmcnt(16)
  v_mfma_f32_16x16x32_bf16 v[172:175], a[216:219], v[40:43], v[172:175]
  ds_read_b128 a[208:211], v2 offset:46080
  v_mfma_f32_16x16x32_bf16 v[200:203], a[216:219], v[44:47], v[200:203]
  v_add_f32 v224, v224, v226
  buffer_load_dwordx4 v[80:83], v2, s[28:31], s60 offen offset:1024 sc1
  buffer_load_dwordx4 v[84:87], v2, s[28:31], s61 offen offset:1024 sc1
  s_waitcnt lgkmcnt(4)
  v_mfma_f32_16x16x32_bf16 v[176:179], a[220:223], v[40:43], v[176:179]
  ds_read_b128 a[212:215], v3 offset:1024
  v_mfma_f32_16x16x32_bf16 v[204:207], a[220:223], v[44:47], v[204:207]
  v_mfma_f32_16x16x32_bf16 v[180:183], a[224:227], v[40:43], v[180:183]
  ds_read_b128 a[216:219], v3 offset:21504
  v_mfma_f32_16x16x32_bf16 v[208:211], a[224:227], v[44:47], v[208:211]
  v_add_f32 v228, v228, v230
  s_waitcnt lgkmcnt(4)
  v_mfma_f32_16x16x32_bf16 v[184:187], a[196:199], v[40:43], v[184:187]
  ds_read_b128 a[220:223], v2 offset:6144
  v_mfma_f32_16x16x32_bf16 v[212:215], a[196:199], v[44:47], v[212:215]
  v_add_f32 v240, v240, v242
  s_waitcnt vmcnt(8)
  v_mfma_f32_16x16x32_bf16 v[168:171], a[200:203], v[48:51], v[168:171]
  ds_read_b128 a[224:227], v2 offset:26624
  v_mfma_f32_16x16x32_bf16 v[196:199], a[200:203], v[52:55], v[196:199]
  v_mov_b32 v226, v224
  v_add_f32 v243, v243, v6
  s_waitcnt lgkmcnt(4)
  v_mfma_f32_16x16x32_bf16 v[172:175], a[204:207], v[48:51], v[172:175]
  ds_read_b128 a[196:199], v2 offset:47104
  v_mfma_f32_16x16x32_bf16 v[200:203], a[204:207], v[52:55], v[200:203]
  v_add_f32 v240, v240, v243
  buffer_load_dwordx4 v[88:91], v2, s[28:31], s60 offen offset:2048 sc1
  buffer_load_dwordx4 v[92:95], v2, s[28:31], s61 offen offset:2048 sc1
  v_mfma_f32_16x16x32_bf16 v[176:179], a[208:211], v[48:51], v[176:179]
  ds_read_b128 a[200:203], v3 offset:2048
  v_mfma_f32_16x16x32_bf16 v[204:207], a[208:211], v[52:55], v[204:207]
  v_mov_b32 v230, v228
  v_cvt_pk_bf16_f32 v242, v240, 0
  s_waitcnt lgkmcnt(4)
  v_mfma_f32_16x16x32_bf16 v[180:183], a[212:215], v[48:51], v[180:183]
  ds_read_b128 a[204:207], v3 offset:22528
  v_mfma_f32_16x16x32_bf16 v[208:211], a[212:215], v[52:55], v[208:211]
  v_lshlrev_b32 v243, 16, v242
  v_mfma_f32_16x16x32_bf16 v[184:187], a[216:219], v[48:51], v[184:187]
  ds_read_b128 a[208:211], v2 offset:7168
  v_mfma_f32_16x16x32_bf16 v[212:215], a[216:219], v[52:55], v[212:215]
  v_permlane16_swap_b32 v224, v226
  v_accvgpr_write_b32 a233, v242
  v_sub_f32 v243, v240, v243
  s_waitcnt vmcnt(8)
  s_waitcnt lgkmcnt(4)
  v_mfma_f32_16x16x32_bf16 v[168:171], a[220:223], v[56:59], v[168:171]
  ds_read_b128 a[212:215], v2 offset:27648
  v_mfma_f32_16x16x32_bf16 v[196:199], a[220:223], v[60:63], v[196:199]
  v_cvt_pk_bf16_f32 v240, v240, v243
  v_accvgpr_write_b32 a234, 0
  v_mfma_f32_16x16x32_bf16 v[172:175], a[224:227], v[56:59], v[172:175]
  ds_read_b128 a[216:219], v2 offset:48128
  v_mfma_f32_16x16x32_bf16 v[200:203], a[224:227], v[60:63], v[200:203]
  v_permlane16_swap_b32 v228, v230
  v_accvgpr_write_b32 a232, v240
  v_accvgpr_write_b32 a235, 0
  buffer_load_dwordx4 v[96:99], v2, s[28:31], s60 offen offset:3072 sc1
  buffer_load_dwordx4 v[100:103], v2, s[28:31], s61 offen offset:3072 sc1
  s_add_u32 s60, s60, 4096
  s_add_u32 s61, s61, 4096
  s_waitcnt lgkmcnt(4)
  v_mfma_f32_16x16x32_bf16 v[176:179], a[196:199], v[56:59], v[176:179]
  ds_read_b128 a[220:223], v3 offset:3072
  v_mfma_f32_16x16x32_bf16 v[204:207], a[196:199], v[60:63], v[204:207]
  ds_read_b32 v240, v241 offset:128
  ds_read_b32 v242, v241 offset:640
  ds_read_b32 v243, v241 offset:1152
  ds_read_b32 v6, v241 offset:1664
  v_mfma_f32_16x16x32_bf16 v[180:183], a[200:203], v[56:59], v[180:183]
  ds_read_b128 a[224:227], v3 offset:23552
  v_mfma_f32_16x16x32_bf16 v[208:211], a[200:203], v[60:63], v[208:211]
  v_add_f32 v224, v224, v226
  s_waitcnt lgkmcnt(4)
  v_mfma_f32_16x16x32_bf16 v[184:187], a[204:207], v[56:59], v[184:187]
  ds_read_b128 a[196:199], v2 offset:8192
  v_mfma_f32_16x16x32_bf16 v[212:215], a[204:207], v[60:63], v[212:215]
  s_waitcnt vmcnt(8)
  v_mfma_f32_16x16x32_bf16 v[168:171], a[208:211], v[64:67], v[168:171]
  ds_read_b128 a[200:203], v2 offset:28672
  v_mfma_f32_16x16x32_bf16 v[196:199], a[208:211], v[68:71], v[196:199]
  v_add_f32 v228, v228, v230
  s_waitcnt lgkmcnt(4)
  v_mfma_f32_16x16x32_bf16 v[172:175], a[212:215], v[64:67], v[172:175]
  ds_read_b128 a[204:207], v2 offset:49152
  v_mfma_f32_16x16x32_bf16 v[200:203], a[212:215], v[68:71], v[200:203]
  buffer_load_dwordx4 v[104:107], v2, s[28:31], s60 offen offset:0 sc1
  buffer_load_dwordx4 v[108:111], v2, s[28:31], s61 offen offset:0 sc1
  v_mfma_f32_16x16x32_bf16 v[176:179], a[216:219], v[64:67], v[176:179]
  ds_read_b128 a[208:211], v3 offset:4096
  v_mfma_f32_16x16x32_bf16 v[204:207], a[216:219], v[68:71], v[204:207]
  v_mov_b32 v226, v224
  s_waitcnt lgkmcnt(4)
  v_mfma_f32_16x16x32_bf16 v[180:183], a[220:223], v[64:67], v[180:183]
  ds_read_b128 a[212:215], v3 offset:24576
  v_mfma_f32_16x16x32_bf16 v[208:211], a[220:223], v[68:71], v[208:211]
  v_mfma_f32_16x16x32_bf16 v[184:187], a[224:227], v[64:67], v[184:187]
  ds_read_b128 a[216:219], v2 offset:9216
  v_mfma_f32_16x16x32_bf16 v[212:215], a[224:227], v[68:71], v[212:215]
  v_mov_b32 v230, v228
  v_add_f32 v240, v240, v242
  s_waitcnt vmcnt(8)
  s_waitcnt lgkmcnt(4)
  v_mfma_f32_16x16x32_bf16 v[168:171], a[196:199], v[72:75], v[168:171]
  ds_read_b128 a[220:223], v2 offset:29696
  v_mfma_f32_16x16x32_bf16 v[196:199], a[196:199], v[76:79], v[196:199]
  v_add_f32 v243, v243, v6
  v_mfma_f32_16x16x32_bf16 v[172:175], a[200:203], v[72:75], v[172:175]
  ds_read_b128 a[224:227], v2 offset:50176
  v_mfma_f32_16x16x32_bf16 v[200:203], a[200:203], v[76:79], v[200:203]
  v_permlane32_swap_b32 v224, v226
  v_add_f32 v240, v240, v243
  buffer_load_dwordx4 v[112:115], v2, s[28:31], s60 offen offset:1024 sc1
  buffer_load_dwordx4 v[116:119], v2, s[28:31], s61 offen offset:1024 sc1
  s_waitcnt lgkmcnt(4)
  v_mfma_f32_16x16x32_bf16 v[176:179], a[204:207], v[72:75], v[176:179]
  ds_read_b128 a[196:199], v3 offset:5120
  v_mfma_f32_16x16x32_bf16 v[204:207], a[204:207], v[76:79], v[204:207]
  v_cvt_pk_bf16_f32 v242, v240, 0
  v_mfma_f32_16x16x32_bf16 v[180:183], a[208:211], v[72:75], v[180:183]
  ds_read_b128 a[200:203], v3 offset:25600
  v_mfma_f32_16x16x32_bf16 v[208:211], a[208:211], v[76:79], v[208:211]
  v_permlane32_swap_b32 v228, v230
  v_lshlrev_b32 v243, 16, v242
  s_waitcnt lgkmcnt(4)
  v_mfma_f32_16x16x32_bf16 v[184:187], a[212:215], v[72:75], v[184:187]
  ds_read_b128 a[204:207], v2 offset:10240
  v_mfma_f32_16x16x32_bf16 v[212:215], a[212:215], v[76:79], v[212:215]
  v_accvgpr_write_b32 a237, v242
  v_sub_f32 v243, v240, v243
  s_waitcnt vmcnt(8)
  v_mfma_f32_16x16x32_bf16 v[168:171], a[216:219], v[80:83], v[168:171]
  ds_read_b128 a[208:211], v2 offset:30720
  v_mfma_f32_16x16x32_bf16 v[196:199], a[216:219], v[84:87], v[196:199]
  v_add_f32 v224, v224, v226
  v_cvt_pk_bf16_f32 v240, v240, v243
  v_accvgpr_write_b32 a238, 0
  s_waitcnt lgkmcnt(4)
  v_mfma_f32_16x16x32_bf16 v[172:175], a[220:223], v[80:83], v[172:175]
  ds_read_b128 a[212:215], v2 offset:51200
  v_mfma_f32_16x16x32_bf16 v[200:203], a[220:223], v[84:87], v[200:203]
  v_accvgpr_write_b32 a236, v240
  v_accvgpr_write_b32 a239, 0
  buffer_load_dwordx4 v[120:123], v2, s[28:31], s60 offen offset:2048 sc1
  buffer_load_dwordx4 v[124:127], v2, s[28:31], s61 offen offset:2048 sc1
  v_mfma_f32_16x16x32_bf16 v[176:179], a[224:227], v[80:83], v[176:179]
  ds_read_b128 a[216:219], v3 offset:6144
  v_mfma_f32_16x16x32_bf16 v[204:207], a[224:227], v[84:87], v[204:207]
  v_add_f32 v228, v228, v230
  ds_read_b32 v240, v241 offset:192
  ds_read_b32 v242, v241 offset:704
  ds_read_b32 v243, v241 offset:1216
  ds_read_b32 v6, v241 offset:1728
  s_waitcnt lgkmcnt(4)
  v_mfma_f32_16x16x32_bf16 v[180:183], a[196:199], v[80:83], v[180:183]
  ds_read_b128 a[220:223], v3 offset:26624
  v_mfma_f32_16x16x32_bf16 v[208:211], a[196:199], v[84:87], v[208:211]
  v_mfma_f32_16x16x32_bf16 v[184:187], a[200:203], v[80:83], v[184:187]
  ds_read_b128 a[224:227], v2 offset:11264
  v_mfma_f32_16x16x32_bf16 v[212:215], a[200:203], v[84:87], v[212:215]
  v_cmp_gt_u32 vcc, 16, v1
  s_waitcnt vmcnt(8)
  s_waitcnt lgkmcnt(4)
  v_mfma_f32_16x16x32_bf16 v[168:171], a[204:207], v[88:91], v[168:171]
  ds_read_b128 a[196:199], v2 offset:31744
  v_mfma_f32_16x16x32_bf16 v[196:199], a[204:207], v[92:95], v[196:199]
  v_mfma_f32_16x16x32_bf16 v[172:175], a[208:211], v[88:91], v[172:175]
  ds_read_b128 a[200:203], v2 offset:52224
  v_mfma_f32_16x16x32_bf16 v[200:203], a[208:211], v[92:95], v[200:203]
  v_mul_f32 v224, 0xbacccccd, v224
  buffer_load_dwordx4 v[128:131], v2, s[28:31], s60 offen offset:3072 sc1
  buffer_load_dwordx4 v[132:135], v2, s[28:31], s61 offen offset:3072 sc1
  s_add_u32 s60, s60, 4096
  s_add_u32 s61, s61, 4096
  s_waitcnt lgkmcnt(4)
  v_mfma_f32_16x16x32_bf16 v[176:179], a[212:215], v[88:91], v[176:179]
  ds_read_b128 a[204:207], v3 offset:7168
  v_mfma_f32_16x16x32_bf16 v[204:207], a[212:215], v[92:95], v[204:207]
  v_mfma_f32_16x16x32_bf16 v[180:183], a[216:219], v[88:91], v[180:183]
  ds_read_b128 a[208:211], v3 offset:27648
  v_mfma_f32_16x16x32_bf16 v[208:211], a[216:219], v[92:95], v[208:211]
  v_cndmask_b32 v224, 0, v224, vcc
  s_waitcnt lgkmcnt(4)
  v_mfma_f32_16x16x32_bf16 v[184:187], a[220:223], v[88:91], v[184:187]
  ds_read_b128 a[212:215], v2 offset:12288
  v_mfma_f32_16x16x32_bf16 v[212:215], a[220:223], v[92:95], v[212:215]
  v_add_f32 v240, v240, v242
  s_waitcnt vmcnt(8)
  v_mfma_f32_16x16x32_bf16 v[168:171], a[224:227], v[96:99], v[168:171]
  ds_read_b128 a[216:219], v2 offset:32768
  v_mfma_f32_16x16x32_bf16 v[196:199], a[224:227], v[100:103], v[196:199]
  v_cvt_pk_bf16_f32 v232, v224, v224
  v_add_f32 v243, v243, v6
  s_waitcnt lgkmcnt(4)
  v_mfma_f32_16x16x32_bf16 v[172:175], a[196:199], v[96:99], v[172:175]
  ds_read_b128 a[220:223], v2 offset:53248
  v_mfma_f32_16x16x32_bf16 v[200:203], a[196:199], v[100:103], v[200:203]
  v_add_f32 v240, v240, v243
  buffer_load_dwordx4 v[136:139], v2, s[28:31], s60 offen offset:0 sc1
  buffer_load_dwordx4 v[140:143], v2, s[28:31], s61 offen offset:0 sc1
  v_mfma_f32_16x16x32_bf16 v[176:179], a[200:203], v[96:99], v[176:179]
  ds_read_b128 a[224:227], v3 offset:8192
  v_mfma_f32_16x16x32_bf16 v[204:207], a[200:203], v[100:103], v[204:207]
  v_lshlrev_b32 v225, 16, v232
  v_cvt_pk_bf16_f32 v242, v240, 0
  s_waitcnt lgkmcnt(4)
  v_mfma_f32_16x16x32_bf16 v[180:183], a[204:207], v[96:99], v[180:183]
  ds_read_b128 a[196:199], v3 offset:28672
  v_mfma_f32_16x16x32_bf16 v[208:211], a[204:207], v[100:103], v[208:211]
  v_lshlrev_b32 v243, 16, v242
  v_mfma_f32_16x16x32_bf16 v[184:187], a[208:211], v[96:99], v[184:187]
  ds_read_b128 a[200:203], v2 offset:13312
  v_mfma_f32_16x16x32_bf16 v[212:215], a[208:211], v[100:103], v[212:215]
  v_sub_f32 v225, v224, v225
  v_accvgpr_write_b32 a241, v242
  v_sub_f32 v243, v240, v243
  s_waitcnt vmcnt(8)
  s_waitcnt lgkmcnt(4)
  v_mfma_f32_16x16x32_bf16 v[168:171], a[212:215], v[104:107], v[168:171]
  ds_read_b128 a[204:207], v2 offset:33792
  v_mfma_f32_16x16x32_bf16 v[196:199], a[212:215], v[108:111], v[196:199]
  v_cvt_pk_bf16_f32 v240, v240, v243
  v_accvgpr_write_b32 a242, 0
  v_mfma_f32_16x16x32_bf16 v[172:175], a[216:219], v[104:107], v[172:175]
  ds_read_b128 a[208:211], v2 offset:54272
  v_mfma_f32_16x16x32_bf16 v[200:203], a[216:219], v[108:111], v[200:203]
  v_cvt_pk_bf16_f32 v233, v225, 0
  v_accvgpr_write_b32 a240, v240
  v_accvgpr_write_b32 a243, 0
  buffer_load_dwordx4 v[144:147], v2, s[28:31], s60 offen offset:1024 sc1
  buffer_load_dwordx4 v[148:151], v2, s[28:31], s61 offen offset:1024 sc1
  s_waitcnt lgkmcnt(4)
  v_mfma_f32_16x16x32_bf16 v[176:179], a[220:223], v[104:107], v[176:179]
  ds_read_b128 a[212:215], v3 offset:9216
  v_mfma_f32_16x16x32_bf16 v[204:207], a[220:223], v[108:111], v[204:207]
  ds_read_b32 v240, v241 offset:256
  ds_read_b32 v242, v241 offset:768
  ds_read_b32 v243, v241 offset:1280
  ds_read_b32 v6, v241 offset:1792
  v_mfma_f32_16x16x32_bf16 v[180:183], a[224:227], v[104:107], v[180:183]
  ds_read_b128 a[216:219], v3 offset:29696
  v_mfma_f32_16x16x32_bf16 v[208:211], a[224:227], v[108:111], v[208:211]
  v_mov_b32 v234, 0
  s_waitcnt lgkmcnt(4)
  v_mfma_f32_16x16x32_bf16 v[184:187], a[196:199], v[104:107], v[184:187]
  ds_read_b128 a[220:223], v2 offset:14336
  v_mfma_f32_16x16x32_bf16 v[212:215], a[196:199], v[108:111], v[212:215]
  s_waitcnt vmcnt(8)
  v_mfma_f32_16x16x32_bf16 v[168:171], a[200:203], v[112:115], v[168:171]
  ds_read_b128 a[224:227], v2 offset:34816
  v_mfma_f32_16x16x32_bf16 v[196:199], a[200:203], v[116:119], v[196:199]
  v_mov_b32 v235, 0
  s_waitcnt lgkmcnt(4)
  v_mfma_f32_16x16x32_bf16 v[172:175], a[204:207], v[112:115], v[172:175]
  ds_read_b128 a[196:199], v2 offset:55296
  v_mfma_f32_16x16x32_bf16 v[200:203], a[204:207], v[116:119], v[200:203]
  buffer_load_dwordx4 v[152:155], v2, s[28:31], s60 offen offset:2048 sc1
  buffer_load_dwordx4 v[156:159], v2, s[28:31], s61 offen offset:2048 sc1
  v_mfma_f32_16x16x32_bf16 v[176:179], a[208:211], v[112:115], v[176:179]
  ds_read_b128 a[200:203], v3 offset:10240
  v_mfma_f32_16x16x32_bf16 v[204:207], a[208:211], v[116:119], v[204:207]
  v_mul_f32 v228, 0xbacccccd, v228
  s_waitcnt lgkmcnt(4)
  v_mfma_f32_16x16x32_bf16 v[180:183], a[212:215], v[112:115], v[180:183]
  ds_read_b128 a[204:207], v3 offset:30720
  v_mfma_f32_16x16x32_bf16 v[208:211], a[212:215], v[116:119], v[208:211]
  v_mfma_f32_16x16x32_bf16 v[184:187], a[216:219], v[112:115], v[184:187]
  ds_read_b128 a[208:211], v2 offset:15360
  v_mfma_f32_16x16x32_bf16 v[212:215], a[216:219], v[116:119], v[212:215]
  v_cndmask_b32 v228, 0, v228, vcc
  v_add_f32 v240, v240, v242
  s_waitcnt vmcnt(8)
  s_waitcnt lgkmcnt(4)
  v_mfma_f32_16x16x32_bf16 v[168:171], a[220:223], v[120:123], v[168:171]
  ds_read_b128 a[212:215], v2 offset:35840
  v_mfma_f32_16x16x32_bf16 v[196:199], a[220:223], v[124:127], v[196:199]
  v_add_f32 v243, v243, v6
  v_mfma_f32_16x16x32_bf16 v[172:175], a[224:227], v[120:123], v[172:175]
  ds_read_b128 a[216:219], v2 offset:56320
  v_mfma_f32_16x16x32_bf16 v[200:203], a[224:227], v[124:127], v[200:203]
  v_cvt_pk_bf16_f32 v236, v228, v228
  v_add_f32 v240, v240, v243
  buffer_load_dwordx4 v[160:163], v2, s[28:31], s60 offen offset:3072 sc1
  buffer_load_dwordx4 v[164:167], v2, s[28:31], s61 offen offset:3072 sc1
  s_waitcnt lgkmcnt(4)
  v_mfma_f32_16x16x32_bf16 v[176:179], a[196:199], v[120:123], v[176:179]
  ds_read_b128 a[220:223], v3 offset:11264
  v_mfma_f32_16x16x32_bf16 v[204:207], a[196:199], v[124:127], v[204:207]
  v_cvt_pk_bf16_f32 v242, v240, 0
  v_mfma_f32_16x16x32_bf16 v[180:183], a[200:203], v[120:123], v[180:183]
  ds_read_b128 a[224:227], v3 offset:31744
  v_mfma_f32_16x16x32_bf16 v[208:211], a[200:203], v[124:127], v[208:211]
  v_lshlrev_b32 v229, 16, v236
  v_lshlrev_b32 v243, 16, v242
  s_waitcnt lgkmcnt(4)
  v_mfma_f32_16x16x32_bf16 v[184:187], a[204:207], v[120:123], v[184:187]
  ds_read_b128 a[196:199], v2 offset:16384
  v_mfma_f32_16x16x32_bf16 v[212:215], a[204:207], v[124:127], v[212:215]
  v_accvgpr_write_b32 a245, v242
  v_sub_f32 v243, v240, v243
  s_waitcnt vmcnt(8)
  v_mfma_f32_16x16x32_bf16 v[168:171], a[208:211], v[128:131], v[168:171]
  ds_read_b128 a[200:203], v2 offset:36864
  v_mfma_f32_16x16x32_bf16 v[196:199], a[208:211], v[132:135], v[196:199]
  v_sub_f32 v229, v228, v229
  v_cvt_pk_bf16_f32 v240, v240, v243
  v_accvgpr_write_b32 a246, 0
  s_waitcnt lgkmcnt(4)
  v_mfma_f32_16x16x32_bf16 v[172:175], a[212:215], v[128:131], v[172:175]
  ds_read_b128 a[204:207], v2 offset:57344
  v_mfma_f32_16x16x32_bf16 v[200:203], a[212:215], v[132:135], v[200:203]
  v_accvgpr_write_b32 a244, v240
  v_accvgpr_write_b32 a247, 0
  v_mfma_f32_16x16x32_bf16 v[176:179], a[216:219], v[128:131], v[176:179]
  ds_read_b128 a[208:211], v3 offset:12288
  v_mfma_f32_16x16x32_bf16 v[204:207], a[216:219], v[132:135], v[204:207]
  v_cvt_pk_bf16_f32 v237, v229, 0
  ds_read_b32 v240, v241 offset:320
  ds_read_b32 v242, v241 offset:832
  ds_read_b32 v243, v241 offset:1344
  ds_read_b32 v6, v241 offset:1856
  s_waitcnt lgkmcnt(4)
  v_mfma_f32_16x16x32_bf16 v[180:183], a[220:223], v[128:131], v[180:183]
  ds_read_b128 a[212:215], v3 offset:32768
  v_mfma_f32_16x16x32_bf16 v[208:211], a[220:223], v[132:135], v[208:211]
  v_mfma_f32_16x16x32_bf16 v[184:187], a[224:227], v[128:131], v[184:187]
  ds_read_b128 a[216:219], v2 offset:17408
  v_mfma_f32_16x16x32_bf16 v[212:215], a[224:227], v[132:135], v[212:215]
  v_mov_b32 v238, 0
  s_waitcnt vmcnt(6)
  s_waitcnt lgkmcnt(4)
  v_mfma_f32_16x16x32_bf16 v[168:171], a[196:199], v[136:139], v[168:171]
  ds_read_b128 a[220:223], v2 offset:37888
  v_mfma_f32_16x16x32_bf16 v[196:199], a[196:199], v[140:143], v[196:199]
  v_mfma_f32_16x16x32_bf16 v[172:175], a[200:203], v[136:139], v[172:175]
  ds_read_b128 a[224:227], v2 offset:58368
  v_mfma_f32_16x16x32_bf16 v[200:203], a[200:203], v[140:143], v[200:203]
  v_mov_b32 v239, 0
  s_waitcnt lgkmcnt(4)
  v_mfma_f32_16x16x32_bf16 v[176:179], a[204:207], v[136:139], v[176:179]
  ds_read_b128 a[196:199], v3 offset:13312
  v_mfma_f32_16x16x32_bf16 v[204:207], a[204:207], v[140:143], v[204:207]
  v_mfma_f32_16x16x32_bf16 v[180:183], a[208:211], v[136:139], v[180:183]
  ds_read_b128 a[200:203], v3 offset:33792
  v_mfma_f32_16x16x32_bf16 v[208:211], a[208:211], v[140:143], v[208:211]
  s_waitcnt lgkmcnt(4)
  v_mfma_f32_16x16x32_bf16 v[184:187], a[212:215], v[136:139], v[184:187]
  ds_read_b128 a[204:207], v2 offset:18432
  v_mfma_f32_16x16x32_bf16 v[212:215], a[212:215], v[140:143], v[212:215]
  v_add_f32 v240, v240, v242
  s_waitcnt vmcnt(4)
  v_mfma_f32_16x16x32_bf16 v[168:171], a[216:219], v[144:147], v[168:171]
  ds_read_b128 a[208:211], v2 offset:38912
  v_mfma_f32_16x16x32_bf16 v[196:199], a[216:219], v[148:151], v[196:199]
  v_add_f32 v243, v243, v6
  s_waitcnt lgkmcnt(4)
  v_mfma_f32_16x16x32_bf16 v[172:175], a[220:223], v[144:147], v[172:175]
  ds_read_b128 a[212:215], v2 offset:59392
  v_mfma_f32_16x16x32_bf16 v[200:203], a[220:223], v[148:151], v[200:203]
  v_add_f32 v240, v240, v243
  v_mfma_f32_16x16x32_bf16 v[176:179], a[224:227], v[144:147], v[176:179]
  ds_read_b128 a[216:219], v3 offset:14336
  v_mfma_f32_16x16x32_bf16 v[204:207], a[224:227], v[148:151], v[204:207]
  v_cvt_pk_bf16_f32 v242, v240, 0
  s_waitcnt lgkmcnt(4)
  v_mfma_f32_16x16x32_bf16 v[180:183], a[196:199], v[144:147], v[180:183]
  ds_read_b128 a[220:223], v3 offset:34816
  v_mfma_f32_16x16x32_bf16 v[208:211], a[196:199], v[148:151], v[208:211]
  v_lshlrev_b32 v243, 16, v242
  v_mfma_f32_16x16x32_bf16 v[184:187], a[200:203], v[144:147], v[184:187]
  ds_read_b128 a[224:227], v2 offset:19456
  v_mfma_f32_16x16x32_bf16 v[212:215], a[200:203], v[148:151], v[212:215]
  v_accvgpr_write_b32 a249, v242
  v_sub_f32 v243, v240, v243
  s_waitcnt vmcnt(2)
  s_waitcnt lgkmcnt(4)
  v_mfma_f32_16x16x32_bf16 v[168:171], a[204:207], v[152:155], v[168:171]
  ds_read_b128 a[196:199], v2 offset:39936
  v_mfma_f32_16x16x32_bf16 v[196:199], a[204:207], v[156:159], v[196:199]
  v_cvt_pk_bf16_f32 v240, v240, v243
  v_accvgpr_write_b32 a250, 0
  v_mfma_f32_16x16x32_bf16 v[172:175], a[208:211], v[152:155], v[172:175]
  ds_read_b128 a[200:203], v2 offset:60416
  v_mfma_f32_16x16x32_bf16 v[200:203], a[208:211], v[156:159], v[200:203]
  v_accvgpr_write_b32 a248, v240
  v_accvgpr_write_b32 a251, 0
  s_waitcnt lgkmcnt(4)
  v_mfma_f32_16x16x32_bf16 v[176:179], a[212:215], v[152:155], v[176:179]
  ds_read_b128 a[204:207], v3 offset:15360
  v_mfma_f32_16x16x32_bf16 v[204:207], a[212:215], v[156:159], v[204:207]
  ds_read_b32 v240, v241 offset:384
  ds_read_b32 v242, v241 offset:896
  ds_read_b32 v243, v241 offset:1408
  ds_read_b32 v6, v241 offset:1920
  v_mfma_f32_16x16x32_bf16 v[180:183], a[216:219], v[152:155], v[180:183]
  ds_read_b128 a[208:211], v3 offset:35840
  v_mfma_f32_16x16x32_bf16 v[208:211], a[216:219], v[156:159], v[208:211]
  s_waitcnt lgkmcnt(4)
  v_mfma_f32_16x16x32_bf16 v[184:187], a[220:223], v[152:155], v[184:187]
  ds_read_b128 a[212:215], v3 offset:36864
  v_mfma_f32_16x16x32_bf16 v[212:215], a[220:223], v[156:159], v[212:215]
  s_waitcnt vmcnt(0)
  v_mfma_f32_16x16x32_bf16 v[168:171], a[224:227], v[160:163], v[168:171]
  ds_read_b128 a[216:219], v3 offset:57344
  v_mfma_f32_16x16x32_bf16 v[196:199], a[224:227], v[164:167], v[196:199]
  s_waitcnt lgkmcnt(4)
  v_mfma_f32_16x16x32_bf16 v[172:175], a[196:199], v[160:163], v[172:175]
  ds_read_b128 a[220:223], v3 offset:37888
  v_mfma_f32_16x16x32_bf16 v[200:203], a[196:199], v[164:167], v[200:203]
  v_mfma_f32_16x16x32_bf16 v[176:179], a[200:203], v[160:163], v[176:179]
  ds_read_b128 a[224:227], v3 offset:58368
  v_mfma_f32_16x16x32_bf16 v[204:207], a[200:203], v[164:167], v[204:207]
  s_waitcnt lgkmcnt(4)
  v_mfma_f32_16x16x32_bf16 v[180:183], a[204:207], v[160:163], v[180:183]
  ds_read_b128 a[196:199], v3 offset:38912
  v_mfma_f32_16x16x32_bf16 v[208:211], a[204:207], v[164:167], v[208:211]
  s_barrier
  v_mfma_f32_16x16x32_bf16 v[184:187], a[208:211], v[160:163], v[184:187]
  ds_read_b128 a[200:203], v3 offset:59392
  v_mfma_f32_16x16x32_bf16 v[212:215], a[208:211], v[164:167], v[212:215]
  v_add_f32 v240, v240, v242
  v_mfma_f32_16x16x32_bf16 v[168:171], a[228:231], v[232:235], v[168:171]
  s_add_u32 s99, s93, 169984
  buffer_load_dwordx4 a[152:155], v2, s[28:31], s99 offen offset:3072 sc1
  v_mfma_f32_16x16x32_bf16 v[172:175], a[232:235], v[232:235], v[172:175]
  v_mfma_f32_16x16x32_bf16 v[176:179], a[236:239], v[232:235], v[176:179]
  v_mfma_f32_16x16x32_bf16 v[180:183], a[240:243], v[232:235], v[180:183]
  v_mfma_f32_16x16x32_bf16 v[184:187], a[244:247], v[232:235], v[184:187]
  v_mfma_f32_16x16x32_bf16 v[196:199], a[228:231], v[236:239], v[196:199]
  v_mfma_f32_16x16x32_bf16 v[200:203], a[232:235], v[236:239], v[200:203]
  s_add_u32 s99, s93, 225280
  buffer_load_dwordx4 a[136:139], v2, s[28:31], s99 offen offset:2048 sc1
  v_mfma_f32_16x16x32_bf16 v[204:207], a[236:239], v[236:239], v[204:207]
  v_mfma_f32_16x16x32_bf16 v[208:211], a[240:243], v[236:239], v[208:211]
  v_mfma_f32_16x16x32_bf16 v[212:215], a[244:247], v[236:239], v[212:215]
  s_waitcnt lgkmcnt(4)
  v_mfma_f32_16x16x32_bf16 v[188:191], a[212:215], v[8:11], 0
  ds_read_b128 a[204:207], v3 offset:39936
  v_mfma_f32_16x16x32_bf16 v[216:219], a[212:215], v[12:15], 0
  v_add_f32 v243, v243, v6
  v_mfma_f32_16x16x32_bf16 v[192:195], a[216:219], v[8:11], 0
  ds_read_b128 a[208:211], v3 offset:60416
  v_mfma_f32_16x16x32_bf16 v[220:223], a[216:219], v[12:15], 0
  s_add_u32 s99, s93, 225280
  buffer_load_dwordx4 a[156:159], v2, s[28:31], s99 offen offset:3072 sc1
  v_add_f32 v240, v240, v243
  s_waitcnt lgkmcnt(4)
  v_mfma_f32_16x16x32_bf16 v[188:191], a[220:223], v[16:19], v[188:191]
  ds_read_b128 a[212:215], v3 offset:40960
  v_mfma_f32_16x16x32_bf16 v[216:219], a[220:223], v[20:23], v[216:219]
  v_cvt_pk_bf16_f32 v242, v240, 0
  v_mfma_f32_16x16x32_bf16 v[192:195], a[224:227], v[16:19], v[192:195]
  ds_read_b128 a[216:219], v3 offset:61440
  v_mfma_f32_16x16x32_bf16 v[220:223], a[224:227], v[20:23], v[220:223]
  v_lshlrev_b32 v243, 16, v242
  s_waitcnt lgkmcnt(4)
  v_mfma_f32_16x16x32_bf16 v[188:191], a[196:199], v[24:27], v[188:191]
  ds_read_b128 a[220:223], v3 offset:41984
  v_mfma_f32_16x16x32_bf16 v[216:219], a[196:199], v[28:31], v[216:219]
  v_accvgpr_write_b32 a253, v242
  v_sub_f32 v243, v240, v243
  v_mfma_f32_16x16x32_bf16 v[192:195], a[200:203], v[24:27], v[192:195]
  s_add_u32 s99, s93, 8192
  buffer_load_dwordx4 a[160:163], v2, s[28:31], s99 offen offset:0 sc1
  ds_read_b128 a[224:227], v3 offset:62464
  v_mfma_f32_16x16x32_bf16 v[220:223], a[200:203], v[28:31], v[220:223]
  v_cvt_pk_bf16_f32 v240, v240, v243
  v_accvgpr_write_b32 a254, 0
  s_waitcnt lgkmcnt(4)
  v_mfma_f32_16x16x32_bf16 v[188:191], a[204:207], v[32:35], v[188:191]
  ds_read_b128 a[196:199], v3 offset:43008
  v_mfma_f32_16x16x32_bf16 v[216:219], a[204:207], v[36:39], v[216:219]
  v_accvgpr_write_b32 a252, v240
  v_accvgpr_write_b32 a255, 0
  v_and_b32 v7, 15, v1
  v_lshrrev_b32 v6, 5, v1
  v_lshlrev_b32 v7, 4, v7
  v_lshl_add_u32 v7, v6, 8, v7
  v_mfma_f32_16x16x32_bf16 v[192:195], a[208:211], v[32:35], v[192:195]
  ds_read_b128 a[200:203], v3 offset:63488
  v_mfma_f32_16x16x32_bf16 v[220:223], a[208:211], v[36:39], v[220:223]
  s_add_u32 s99, s93, 8192
  buffer_load_dwordx4 a[180:183], v2, s[28:31], s99 offen offset:1024 sc1
  v_max_f32 v168, 0, v168
  v_max_f32 v169, 0, v169
  v_max_f32 v170, 0, v170
  v_max_f32 v171, 0, v171
  s_waitcnt lgkmcnt(4)
  v_mfma_f32_16x16x32_bf16 v[188:191], a[212:215], v[40:43], v[188:191]
  ds_read_b128 a[204:207], v3 offset:44032
  v_mfma_f32_16x16x32_bf16 v[216:219], a[212:215], v[44:47], v[216:219]
  v_cvt_pk_bf16_f32 v168, v168, v169
  v_cvt_pk_bf16_f32 v169, v170, v171
  v_max_f32 v172, 0, v172
  v_max_f32 v173, 0, v173
  v_mfma_f32_16x16x32_bf16 v[192:195], a[216:219], v[40:43], v[192:195]
  ds_read_b128 a[208:211], v3 offset:64512
  v_mfma_f32_16x16x32_bf16 v[220:223], a[216:219], v[44:47], v[220:223]
  v_max_f32 v174, 0, v174
  v_max_f32 v175, 0, v175
  v_cvt_pk_bf16_f32 v170, v172, v173
  s_add_u32 s99, s93, 63488
  buffer_load_dwordx4 a[164:167], v2, s[28:31], s99 offen offset:0 sc1
  v_cvt_pk_bf16_f32 v171, v174, v175
  s_waitcnt lgkmcnt(4)
  v_mfma_f32_16x16x32_bf16 v[188:191], a[220:223], v[48:51], v[188:191]
  ds_read_b128 a[212:215], v3 offset:45056
  v_mfma_f32_16x16x32_bf16 v[216:219], a[220:223], v[52:55], v[216:219]
  v_max_f32 v176, 0, v176
  v_max_f32 v177, 0, v177
  v_max_f32 v178, 0, v178
  v_max_f32 v179, 0, v179
  v_mfma_f32_16x16x32_bf16 v[192:195], a[224:227], v[48:51], v[192:195]
  ds_read_b128 a[216:219], v4 offset:0
  v_mfma_f32_16x16x32_bf16 v[220:223], a[224:227], v[52:55], v[220:223]
  v_cvt_pk_bf16_f32 v172, v176, v177
  v_cvt_pk_bf16_f32 v173, v178, v179
  v_max_f32 v180, 0, v180
  v_max_f32 v181, 0, v181
  s_waitcnt lgkmcnt(4)
  v_mfma_f32_16x16x32_bf16 v[188:191], a[196:199], v[56:59], v[188:191]
  s_add_u32 s99, s93, 63488
  buffer_load_dwordx4 a[184:187], v2, s[28:31], s99 offen offset:1024 sc1
  ds_read_b128 a[220:223], v3 offset:46080
  v_mfma_f32_16x16x32_bf16 v[216:219], a[196:199], v[60:63], v[216:219]
  v_max_f32 v182, 0, v182
  v_max_f32 v183, 0, v183
  v_cvt_pk_bf16_f32 v174, v180, v181
  v_cvt_pk_bf16_f32 v175, v182, v183
  v_mfma_f32_16x16x32_bf16 v[192:195], a[200:203], v[56:59], v[192:195]
  ds_read_b128 a[224:227], v4 offset:1024
  v_mfma_f32_16x16x32_bf16 v[220:223], a[200:203], v[60:63], v[220:223]
  v_max_f32 v184, 0, v184
  v_max_f32 v185, 0, v185
  v_max_f32 v186, 0, v186
  v_max_f32 v187, 0, v187
  s_waitcnt lgkmcnt(4)
  v_mfma_f32_16x16x32_bf16 v[188:191], a[204:207], v[64:67], v[188:191]
  ds_read_b128 a[196:199], v3 offset:47104
  v_mfma_f32_16x16x32_bf16 v[216:219], a[204:207], v[68:71], v[216:219]
  s_add_u32 s99, s93, 118784
  buffer_load_dwordx4 a[168:171], v2, s[28:31], s99 offen offset:0 sc1
  v_cvt_pk_bf16_f32 v176, v184, v185
  v_cvt_pk_bf16_f32 v177, v186, v187
  v_max_f32 v196, 0, v196
  v_max_f32 v197, 0, v197
  v_mfma_f32_16x16x32_bf16 v[192:195], a[208:211], v[64:67], v[192:195]
  ds_read_b128 a[200:203], v4 offset:2048
  v_mfma_f32_16x16x32_bf16 v[220:223], a[208:211], v[68:71], v[220:223]
  v_max_f32 v198, 0, v198
  v_max_f32 v199, 0, v199
  v_cvt_pk_bf16_f32 v196, v196, v197
  v_cvt_pk_bf16_f32 v197, v198, v199
  s_waitcnt lgkmcnt(4)
  v_mfma_f32_16x16x32_bf16 v[188:191], a[212:215], v[72:75], v[188:191]
  ds_read_b128 a[204:207], v3 offset:48128
  v_mfma_f32_16x16x32_bf16 v[216:219], a[212:215], v[76:79], v[216:219]
  v_max_f32 v200, 0, v200
  v_max_f32 v201, 0, v201
  v_max_f32 v202, 0, v202
  v_max_f32 v203, 0, v203
  s_add_u32 s99, s93, 118784
  buffer_load_dwordx4 a[188:191], v2, s[28:31], s99 offen offset:1024 sc1
  v_mfma_f32_16x16x32_bf16 v[192:195], a[216:219], v[72:75], v[192:195]
  ds_read_b128 a[208:211], v4 offset:3072
  v_mfma_f32_16x16x32_bf16 v[220:223], a[216:219], v[76:79], v[220:223]
  v_cvt_pk_bf16_f32 v198, v200, v201
  v_cvt_pk_bf16_f32 v199, v202, v203
  v_max_f32 v204, 0, v204
  v_max_f32 v205, 0, v205
  s_waitcnt lgkmcnt(4)
  v_mfma_f32_16x16x32_bf16 v[188:191], a[220:223], v[80:83], v[188:191]
  ds_read_b128 a[212:215], v3 offset:49152
  v_mfma_f32_16x16x32_bf16 v[216:219], a[220:223], v[84:87], v[216:219]
  v_max_f32 v206, 0, v206
  v_max_f32 v207, 0, v207
  v_cvt_pk_bf16_f32 v200, v204, v205
  v_cvt_pk_bf16_f32 v201, v206, v207
  v_mfma_f32_16x16x32_bf16 v[192:195], a[224:227], v[80:83], v[192:195]
  s_add_u32 s99, s93, 174080
  buffer_load_dwordx4 a[172:175], v2, s[28:31], s99 offen offset:0 sc1
  ds_read_b128 a[216:219], v4 offset:4096
  v_mfma_f32_16x16x32_bf16 v[220:223], a[224:227], v[84:87], v[220:223]
  v_max_f32 v208, 0, v208
  v_max_f32 v209, 0, v209
  v_max_f32 v210, 0, v210
  v_max_f32 v211, 0, v211
  s_waitcnt lgkmcnt(4)
  v_mfma_f32_16x16x32_bf16 v[188:191], a[196:199], v[88:91], v[188:191]
  ds_read_b128 a[220:223], v3 offset:50176
  v_mfma_f32_16x16x32_bf16 v[216:219], a[196:199], v[92:95], v[216:219]
  v_cvt_pk_bf16_f32 v202, v208, v209
  v_cvt_pk_bf16_f32 v203, v210, v211
  v_max_f32 v212, 0, v212
  v_max_f32 v213, 0, v213
  v_mfma_f32_16x16x32_bf16 v[192:195], a[200:203], v[88:91], v[192:195]
  ds_read_b128 a[224:227], v4 offset:5120
  v_mfma_f32_16x16x32_bf16 v[220:223], a[200:203], v[92:95], v[220:223]
  s_add_u32 s99, s93, 174080
  buffer_load_dwordx4 a[192:195], v2, s[28:31], s99 offen offset:1024 sc1
  v_max_f32 v214, 0, v214
  v_max_f32 v215, 0, v215
  v_cvt_pk_bf16_f32 v204, v212, v213
  v_cvt_pk_bf16_f32 v205, v214, v215
  s_bitcmp1_b32 s50, 0
  s_cbranch_scc1 L_eo_28
  buffer_store_dwordx4 v[168:171], v2, s[28:31], s66 offen offset:0 sc1
  buffer_store_dwordx4 v[172:175], v2, s[28:31], s66 offen offset:1024 sc1
  buffer_store_dwordx4 v[196:199], v2, s[28:31], s67 offen offset:0 sc1
  buffer_store_dwordx4 v[200:203], v2, s[28:31], s67 offen offset:1024 sc1
  s_branch L_ee_29
L_eo_28:
  buffer_store_dwordx4 v[170:173], v2, s[28:31], s68 offen sc1
  v_mov_b32 v182, v168
  v_mov_b32 v183, v169
  v_mov_b32 v184, v168
  v_mov_b32 v185, v169
  s_nop 0
  v_permlane16_swap_b32 v182, v184
  v_permlane16_swap_b32 v183, v185
  s_mov_b32 exec_lo, 0xffff
  s_mov_b32 exec_hi, 0xffff
  buffer_store_dwordx4 v[182:185], v7, s[28:31], s66 offen offset:3584 sc1
  s_mov_b64 exec, -1
  buffer_store_dwordx4 v[198:201], v2, s[28:31], s69 offen sc1
  v_mov_b32 v210, v196
  v_mov_b32 v211, v197
  v_mov_b32 v212, v196
  v_mov_b32 v213, v197
  s_nop 0
  v_permlane16_swap_b32 v210, v212
  v_permlane16_swap_b32 v211, v213
  s_mov_b32 exec_lo, 0xffff
  s_mov_b32 exec_hi, 0xffff
  buffer_store_dwordx4 v[210:213], v7, s[28:31], s67 offen offset:3584 sc1
  s_mov_b64 exec, -1
  s_cmp_eq_u32 s50, 15
  s_cbranch_scc1 L_ee_29
  buffer_store_dwordx4 v[174:177], v2, s[28:31], s68 offen offset:1024 sc1
  buffer_store_dwordx4 v[202:205], v2, s[28:31], s69 offen offset:1024 sc1
L_ee_29:
  s_waitcnt lgkmcnt(4)
  v_mfma_f32_16x16x32_bf16 v[188:191], a[204:207], v[96:99], v[188:191]
  ds_read_b128 a[196:199], v3 offset:51200
  v_mfma_f32_16x16x32_bf16 v[216:219], a[204:207], v[100:103], v[216:219]
  v_mfma_f32_16x16x32_bf16 v[192:195], a[208:211], v[96:99], v[192:195]
  ds_read_b128 a[200:203], v4 offset:6144
  v_mfma_f32_16x16x32_bf16 v[220:223], a[208:211], v[100:103], v[220:223]
  s_waitcnt lgkmcnt(4)
  v_mfma_f32_16x16x32_bf16 v[188:191], a[212:215], v[104:107], v[188:191]
  ds_read_b128 a[204:207], v3 offset:52224
  v_mfma_f32_16x16x32_bf16 v[216:219], a[212:215], v[108:111], v[216:219]
  s_add_u32 s99, s93, 229376
  buffer_load_dwordx4 a[176:179], v2, s[28:31], s99 offen offset:0 sc1
  v_mfma_f32_16x16x32_bf16 v[192:195], a[216:219], v[104:107], v[192:195]
  ds_read_b128 a[208:211], v4 offset:7168
  v_mfma_f32_16x16x32_bf16 v[220:223], a[216:219], v[108:111], v[220:223]
  s_waitcnt lgkmcnt(4)
  v_mfma_f32_16x16x32_bf16 v[188:191], a[220:223], v[112:115], v[188:191]
  ds_read_b128 a[212:215], v3 offset:53248
  v_mfma_f32_16x16x32_bf16 v[216:219], a[220:223], v[116:119], v[216:219]
  v_mfma_f32_16x16x32_bf16 v[192:195], a[224:227], v[112:115], v[192:195]
  ds_read_b128 a[216:219], v4 offset:8192
  v_mfma_f32_16x16x32_bf16 v[220:223], a[224:227], v[116:119], v[220:223]
  s_waitcnt lgkmcnt(4)
  v_mfma_f32_16x16x32_bf16 v[188:191], a[196:199], v[120:123], v[188:191]
  ds_read_b128 a[220:223], v3 offset:54272
  v_mfma_f32_16x16x32_bf16 v[216:219], a[196:199], v[124:127], v[216:219]
  v_mfma_f32_16x16x32_bf16 v[192:195], a[200:203], v[120:123], v[192:195]
  ds_read_b128 a[224:227], v4 offset:9216
  v_mfma_f32_16x16x32_bf16 v[220:223], a[200:203], v[124:127], v[220:223]
  s_waitcnt lgkmcnt(4)
  v_mfma_f32_16x16x32_bf16 v[188:191], a[204:207], v[128:131], v[188:191]
  ds_read_b128 a[196:199], v3 offset:55296
  v_mfma_f32_16x16x32_bf16 v[216:219], a[204:207], v[132:135], v[216:219]
  v_mfma_f32_16x16x32_bf16 v[192:195], a[208:211], v[128:131], v[192:195]
  ds_read_b128 a[200:203], v4 offset:10240
  v_mfma_f32_16x16x32_bf16 v[220:223], a[208:211], v[132:135], v[220:223]
  s_waitcnt lgkmcnt(4)
  v_mfma_f32_16x16x32_bf16 v[188:191], a[212:215], v[136:139], v[188:191]
  ds_read_b128 a[204:207], v3 offset:56320
  v_mfma_f32_16x16x32_bf16 v[216:219], a[212:215], v[140:143], v[216:219]
  v_mfma_f32_16x16x32_bf16 v[192:195], a[216:219], v[136:139], v[192:195]
  ds_read_b128 a[208:211], v4 offset:11264
  v_mfma_f32_16x16x32_bf16 v[220:223], a[216:219], v[140:143], v[220:223]
  s_waitcnt lgkmcnt(4)
  v_mfma_f32_16x16x32_bf16 v[188:191], a[220:223], v[144:147], v[188:191]
  v_mfma_f32_16x16x32_bf16 v[216:219], a[220:223], v[148:151], v[216:219]
  v_mfma_f32_16x16x32_bf16 v[192:195], a[224:227], v[144:147], v[192:195]
  v_mfma_f32_16x16x32_bf16 v[220:223], a[224:227], v[148:151], v[220:223]
  s_waitcnt lgkmcnt(2)
  v_mfma_f32_16x16x32_bf16 v[188:191], a[196:199], v[152:155], v[188:191]
  v_mfma_f32_16x16x32_bf16 v[216:219], a[196:199], v[156:159], v[216:219]
  v_mfma_f32_16x16x32_bf16 v[192:195], a[200:203], v[152:155], v[192:195]
  v_mfma_f32_16x16x32_bf16 v[220:223], a[200:203], v[156:159], v[220:223]
  s_waitcnt lgkmcnt(0)
  v_mfma_f32_16x16x32_bf16 v[188:191], a[204:207], v[160:163], v[188:191]
  v_mfma_f32_16x16x32_bf16 v[216:219], a[204:207], v[164:167], v[216:219]
  v_mfma_f32_16x16x32_bf16 v[192:195], a[208:211], v[160:163], v[192:195]
  v_mfma_f32_16x16x32_bf16 v[220:223], a[208:211], v[164:167], v[220:223]
  v_mfma_f32_16x16x32_bf16 v[188:191], a[248:251], v[232:235], v[188:191]
  v_mfma_f32_16x16x32_bf16 v[192:195], a[252:255], v[232:235], v[192:195]
  v_mfma_f32_16x16x32_bf16 v[216:219], a[248:251], v[236:239], v[216:219]
  v_mfma_f32_16x16x32_bf16 v[220:223], a[252:255], v[236:239], v[220:223]
  s_nop 4
  v_cvt_pk_bf16_f32 v178, v188, v189
  v_cvt_pk_bf16_f32 v179, v190, v191
  v_cvt_pk_bf16_f32 v180, v192, v193
  v_cvt_pk_bf16_f32 v181, v194, v195
  v_pk_max_i16 v178, v178, 0
  v_pk_max_i16 v179, v179, 0
  v_pk_max_i16 v180, v180, 0
  v_pk_max_i16 v181, v181, 0
  v_cvt_pk_bf16_f32 v206, v216, v217
  v_cvt_pk_bf16_f32 v207, v218, v219
  v_cvt_pk_bf16_f32 v208, v220, v221
  v_cvt_pk_bf16_f32 v209, v222, v223
  v_pk_max_i16 v206, v206, 0
  v_pk_max_i16 v207, v207, 0
  v_pk_max_i16 v208, v208, 0
  v_pk_max_i16 v209, v209, 0
  s_bitcmp1_b32 s50, 0
  s_cbranch_scc1 L_c15_30
  buffer_store_dwordx4 v[176:179], v2, s[28:31], s66 offen offset:2048 sc1
  v_mov_b32 v182, v180
  v_mov_b32 v183, v181
  v_mov_b32 v184, v180
  v_mov_b32 v185, v181
  s_nop 0
  v_permlane16_swap_b32 v182, v184
  v_permlane16_swap_b32 v183, v185
  s_mov_b32 exec_lo, 0xffff
  s_mov_b32 exec_hi, 0xffff
  buffer_store_dwordx4 v[182:185], v7, s[28:31], s66 offen offset:3072 sc1
  s_mov_b64 exec, -1
  buffer_store_dwordx4 v[204:207], v2, s[28:31], s67 offen offset:2048 sc1
  v_mov_b32 v210, v208
  v_mov_b32 v211, v209
  v_mov_b32 v212, v208
  v_mov_b32 v213, v209
  s_nop 0
  v_permlane16_swap_b32 v210, v212
  v_permlane16_swap_b32 v211, v213
  s_mov_b32 exec_lo, 0xffff
  s_mov_b32 exec_hi, 0xffff
  buffer_store_dwordx4 v[210:213], v7, s[28:31], s67 offen offset:3072 sc1
  s_mov_b64 exec, -1
  s_branch L_ce_31
L_c15_30:
  s_cmp_eq_u32 s50, 15
  s_cbranch_scc1 L_ce_31
  buffer_store_dwordx4 v[178:181], v2, s[28:31], s68 offen offset:2048 sc1
  buffer_store_dwordx4 v[206:209], v2, s[28:31], s69 offen offset:2048 sc1
L_ce_31:
  s_lshr_b32 s62, s50, 1
  s_and_b32 s63, s50, 1
  s_lshl_b32 s64, s49, 3
  s_lshl_b32 s55, s63, 2
  s_add_u32 s64, s64, s55
  s_add_u32 s55, s48, 0
  s_and_b32 s55, s55, 3
  s_add_u32 s56, s55, s64
  s_mul_i32 s66, s56, 55296
  s_add_u32 s66, s66, s52
  s_add_u32 s66, s66, 11878400
  s_mul_i32 s55, s55, 15360
  s_add_u32 s55, s55, 0
  v_add_u32 v240, s55, v2
  s_add_u32 s55, s48, 1
  s_and_b32 s55, s55, 3
  s_add_u32 s56, s55, s64
  s_mul_i32 s67, s56, 55296
  s_add_u32 s67, s67, s52
  s_add_u32 s67, s67, 11878400
  s_mul_i32 s55, s55, 15360
  s_add_u32 s55, s55, 0
  v_add_u32 v241, s55, v2
  s_add_u32 s55, s48, 2
  s_and_b32 s55, s55, 3
  s_add_u32 s56, s55, s64
  s_mul_i32 s68, s56, 55296
  s_add_u32 s68, s68, s52
  s_add_u32 s68, s68, 11878400
  s_mul_i32 s55, s55, 15360
  s_add_u32 s55, s55, 5120
  v_add_u32 v242, s55, v2
  s_add_u32 s55, s48, 3
  s_and_b32 s55, s55, 3
  s_add_u32 s56, s55, s64
  s_mul_i32 s69, s56, 55296
  s_add_u32 s69, s69, s52
  s_add_u32 s69, s69, 11878400
  s_mul_i32 s55, s55, 15360
  s_add_u32 s55, s55, 10240
  v_add_u32 v243, s55, v2
  s_add_u32 s55, s64, s48
  s_lshl_b32 s61, s55, 10
  s_add_u32 s61, s61, 23920640
  s_mul_i32 s60, s55, 20480
  s_mul_i32 s55, s62, 160
  s_add_u32 s60, s60, s55
  s_lshl_b32 s58, s49, 7
  s_add_u32 s58, s58, 24334336
  s_lshl_b32 s59, s50, 2
  v_mov_b32 v6, s59
  v_mov_b32 v7, s51
  s_cmp_lg_u32 s48, 0
  s_waitcnt vmcnt(0)
  s_barrier
  s_cbranch_scc1 L_sig_35
  s_mov_b64 exec, 1
  buffer_store_dword v7, v6, s[28:31], s58 offen sc1
  s_mov_b64 exec, -1
L_sig_35:
  buffer_load_dwordx2 v[200:201], v5, s[28:31], s61 offen offset:0 sc1
  buffer_load_dwordx2 v[202:203], v5, s[28:31], s61 offen offset:128 sc1
  s_add_u32 s99, s93, 229376
  buffer_load_dwordx4 a[196:199], v2, s[28:31], s99 offen offset:1024 sc1
  s_add_u32 s99, s93, 8192
  buffer_load_dwordx4 a[200:203], v2, s[28:31], s99 offen offset:2048 sc1
  s_add_u32 s99, s93, 8192
  buffer_load_dwordx4 a[220:223], v2, s[28:31], s99 offen offset:3072 sc1
  s_add_u32 s99, s93, 63488
  buffer_load_dwordx4 a[204:207], v2, s[28:31], s99 offen offset:2048 sc1
  s_add_u32 s99, s93, 63488
  buffer_load_dwordx4 a[224:227], v2, s[28:31], s99 offen offset:3072 sc1
  s_add_u32 s99, s93, 118784
  buffer_load_dwordx4 a[208:211], v2, s[28:31], s99 offen offset:2048 sc1
  s_add_u32 s99, s93, 118784
  buffer_load_dwordx4 a[228:231], v2, s[28:31], s99 offen offset:3072 sc1
  s_add_u32 s99, s93, 174080
  buffer_load_dwordx4 a[212:215], v2, s[28:31], s99 offen offset:2048 sc1
  s_add_u32 s99, s93, 174080
  buffer_load_dwordx4 a[232:235], v2, s[28:31], s99 offen offset:3072 sc1
  s_add_u32 s99, s93, 229376
  buffer_load_dwordx4 a[216:219], v2, s[28:31], s99 offen offset:2048 sc1
  s_add_u32 s99, s93, 229376
  buffer_load_dwordx4 a[236:239], v2, s[28:31], s99 offen offset:3072 sc1
  s_add_u32 s99, s93, 12288
  buffer_load_dwordx4 a[240:243], v2, s[28:31], s99 offen offset:0 sc1
  s_add_u32 s99, s93, 67584
  buffer_load_dwordx4 a[244:247], v2, s[28:31], s99 offen offset:0 sc1
  s_add_u32 s99, s93, 122880
  buffer_load_dwordx4 a[248:251], v2, s[28:31], s99 offen offset:0 sc1
  s_waitcnt vmcnt(14)
  v_add_f32 v200, v200, v202
  v_add_f32 v201, v201, v203
  v_mov_b32 v202, v200
  v_mov_b32 v203, v201
  s_nop 0
  v_permlane16_swap_b32 v200, v202
  v_permlane16_swap_b32 v201, v203
  v_add_f32 v200, v200, v202
  v_add_f32 v201, v201, v203
  v_mov_b32 v202, v200
  v_mov_b32 v203, v201
  s_nop 0
  v_permlane32_swap_b32 v200, v202
  v_permlane32_swap_b32 v201, v203
  v_add_f32 v200, v200, v202
  v_add_f32 v201, v201, v203
  v_mul_f32 v200, 0x3acccccd, v200
  v_mul_f32 v201, 0x3acccccd, v201
  v_fma_f32 v202, -v200, v200, v201
  v_max_f32 v202, 0, v202
  v_add_f32 v202, 0x3727c5ac, v202
  v_rsq_f32 v202, v202
  s_nop 0
  v_mul_f32 v201, -v200, v202
  v_mov_b32 v200, v202
  v_mov_b32 v5, v200
  s_cmp_lg_u32 s48, 0
  s_cbranch_scc1 L_wt_36
  s_lshl_b32 s58, s49, 7
  s_add_u32 s58, s58, 24334336
  v_lshlrev_b32 v6, 2, v1
  s_mov_b64 exec, 0xffff
  s_mov_b32 s57, 0
L_poll_37:
  buffer_load_dword v7, v6, s[28:31], s58 offen sc1
  s_add_u32 s57, s57, 1
  s_waitcnt vmcnt(0)
  v_cmp_ne_u32 vcc, s51, v7
  s_cmp_ge_u32 s57, 32768
  s_cbranch_scc1 L_pd_38
  s_cbranch_vccnz L_poll_37
L_pd_38:
  s_mov_b64 exec, -1
L_wt_36:
  s_barrier
  buffer_load_dwordx4 v[88:91], v2, s[28:31], s66 offen offset:0 sc1
  buffer_load_dwordx4 v[92:95], v2, s[28:31], s67 offen offset:0 sc1
  buffer_load_dwordx4 v[96:99], v2, s[28:31], s68 offen offset:0 sc1
  buffer_load_dwordx4 v[100:103], v2, s[28:31], s69 offen offset:0 sc1
  buffer_load_dwordx4 v[104:107], v2, s[28:31], s66 offen offset:1024 sc1
  buffer_load_dwordx4 v[108:111], v2, s[28:31], s67 offen offset:1024 sc1
  buffer_load_dwordx4 v[112:115], v2, s[28:31], s68 offen offset:1024 sc1
  buffer_load_dwordx4 v[116:119], v2, s[28:31], s69 offen offset:1024 sc1
  buffer_load_dwordx4 v[120:123], v2, s[28:31], s66 offen offset:2048 sc1
  buffer_load_dwordx4 v[124:127], v2, s[28:31], s67 offen offset:2048 sc1
  buffer_load_dwordx4 v[128:131], v2, s[28:31], s68 offen offset:2048 sc1
  buffer_load_dwordx4 v[132:135], v2, s[28:31], s69 offen offset:2048 sc1
  s_waitcnt vmcnt(11)
  v_mfma_f32_16x16x32_bf16 v[8:11], a[0:3], v[88:91], 0
  v_mfma_f32_16x16x32_bf16 v[12:15], a[4:7], v[88:91], 0
  buffer_load_dwordx4 v[136:139], v2, s[28:31], s66 offen offset:3072 sc1
  v_mfma_f32_16x16x32_bf16 v[16:19], a[8:11], v[88:91], 0
  v_mfma_f32_16x16x32_bf16 v[20:23], a[12:15], v[88:91], 0
  s_add_u32 s99, s93, 178176
  buffer_load_dwordx4 a[252:255], v2, s[28:31], s99 offen offset:0 sc1
  v_mfma_f32_16x16x32_bf16 v[24:27], a[16:19], v[88:91], 0
  s_waitcnt vmcnt(12)
  v_mfma_f32_16x16x32_bf16 v[28:31], a[0:3], v[92:95], 0
  v_mfma_f32_16x16x32_bf16 v[32:35], a[4:7], v[92:95], 0
  buffer_load_dwordx4 v[140:143], v2, s[28:31], s67 offen offset:3072 sc1
  v_mfma_f32_16x16x32_bf16 v[36:39], a[8:11], v[92:95], 0
  v_mfma_f32_16x16x32_bf16 v[40:43], a[12:15], v[92:95], 0
  s_add_u32 s99, s93, 233472
  buffer_load_dwordx4 v[216:219], v2, s[28:31], s99 offen offset:0 sc1
  v_mfma_f32_16x16x32_bf16 v[44:47], a[16:19], v[92:95], 0
  s_waitcnt vmcnt(13)
  v_mfma_f32_16x16x32_bf16 v[48:51], a[0:3], v[96:99], 0
  v_mfma_f32_16x16x32_bf16 v[52:55], a[4:7], v[96:99], 0
  buffer_load_dwordx4 v[144:147], v2, s[28:31], s68 offen offset:3072 sc1
  v_mfma_f32_16x16x32_bf16 v[56:59], a[8:11], v[96:99], 0
  v_mfma_f32_16x16x32_bf16 v[60:63], a[12:15], v[96:99], 0
  v_mfma_f32_16x16x32_bf16 v[64:67], a[16:19], v[96:99], 0
  s_waitcnt vmcnt(13)
  v_mfma_f32_16x16x32_bf16 v[68:71], a[0:3], v[100:103], 0
  v_mfma_f32_16x16x32_bf16 v[72:75], a[4:7], v[100:103], 0
  buffer_load_dwordx4 v[148:151], v2, s[28:31], s69 offen offset:3072 sc1
  v_mfma_f32_16x16x32_bf16 v[76:79], a[8:11], v[100:103], 0
  v_mfma_f32_16x16x32_bf16 v[80:83], a[12:15], v[100:103], 0
  v_mfma_f32_16x16x32_bf16 v[84:87], a[16:19], v[100:103], 0
  s_waitcnt vmcnt(13)
  v_mfma_f32_16x16x32_bf16 v[8:11], a[20:23], v[104:107], v[8:11]
  v_mfma_f32_16x16x32_bf16 v[12:15], a[24:27], v[104:107], v[12:15]
  s_add_u32 s55, s66, 4096
  buffer_load_dwordx4 v[152:155], v2, s[28:31], s55 offen offset:0 sc1
  v_mfma_f32_16x16x32_bf16 v[16:19], a[28:31], v[104:107], v[16:19]
  v_mfma_f32_16x16x32_bf16 v[20:23], a[32:35], v[104:107], v[20:23]
  v_mfma_f32_16x16x32_bf16 v[24:27], a[36:39], v[104:107], v[24:27]
  s_waitcnt vmcnt(13)
  v_mfma_f32_16x16x32_bf16 v[28:31], a[20:23], v[108:111], v[28:31]
  v_mfma_f32_16x16x32_bf16 v[32:35], a[24:27], v[108:111], v[32:35]
  s_add_u32 s55, s67, 4096
  buffer_load_dwordx4 v[156:159], v2, s[28:31], s55 offen offset:0 sc1
  v_mfma_f32_16x16x32_bf16 v[36:39], a[28:31], v[108:111], v[36:39]
  v_mfma_f32_16x16x32_bf16 v[40:43], a[32:35], v[108:111], v[40:43]
  v_mfma_f32_16x16x32_bf16 v[44:47], a[36:39], v[108:111], v[44:47]
  s_waitcnt vmcnt(13)
  v_mfma_f32_16x16x32_bf16 v[48:51], a[20:23], v[112:115], v[48:51]
  v_mfma_f32_16x16x32_bf16 v[52:55], a[24:27], v[112:115], v[52:55]
  s_add_u32 s55, s68, 4096
  buffer_load_dwordx4 v[160:163], v2, s[28:31], s55 offen offset:0 sc1
  v_mfma_f32_16x16x32_bf16 v[56:59], a[28:31], v[112:115], v[56:59]
  v_mfma_f32_16x16x32_bf16 v[60:63], a[32:35], v[112:115], v[60:63]
  v_mfma_f32_16x16x32_bf16 v[64:67], a[36:39], v[112:115], v[64:67]
  s_waitcnt vmcnt(13)
  v_mfma_f32_16x16x32_bf16 v[68:71], a[20:23], v[116:119], v[68:71]
  v_mfma_f32_16x16x32_bf16 v[72:75], a[24:27], v[116:119], v[72:75]
  s_add_u32 s55, s69, 4096
  buffer_load_dwordx4 v[164:167], v2, s[28:31], s55 offen offset:0 sc1
  v_mfma_f32_16x16x32_bf16 v[76:79], a[28:31], v[116:119], v[76:79]
  v_mfma_f32_16x16x32_bf16 v[80:83], a[32:35], v[116:119], v[80:83]
  v_mfma_f32_16x16x32_bf16 v[84:87], a[36:39], v[116:119], v[84:87]
  s_waitcnt vmcnt(13)
  v_mfma_f32_16x16x32_bf16 v[8:11], a[40:43], v[120:123], v[8:11]
  v_mfma_f32_16x16x32_bf16 v[12:15], a[44:47], v[120:123], v[12:15]
  s_add_u32 s55, s67, 4096
  buffer_load_dwordx4 v[168:171], v2, s[28:31], s55 offen offset:1024 sc1
  v_mfma_f32_16x16x32_bf16 v[16:19], a[48:51], v[120:123], v[16:19]
  v_mfma_f32_16x16x32_bf16 v[20:23], a[52:55], v[120:123], v[20:23]
  v_mfma_f32_16x16x32_bf16 v[24:27], a[56:59], v[120:123], v[24:27]
  s_waitcnt vmcnt(13)
  v_mfma_f32_16x16x32_bf16 v[28:31], a[40:43], v[124:127], v[28:31]
  v_mfma_f32_16x16x32_bf16 v[32:35], a[44:47], v[124:127], v[32:35]
  s_add_u32 s55, s68, 4096
  buffer_load_dwordx4 v[172:175], v2, s[28:31], s55 offen offset:1024 sc1
  v_mfma_f32_16x16x32_bf16 v[36:39], a[48:51], v[124:127], v[36:39]
  v_mfma_f32_16x16x32_bf16 v[40:43], a[52:55], v[124:127], v[40:43]
  v_mfma_f32_16x16x32_bf16 v[44:47], a[56:59], v[124:127], v[44:47]
  s_waitcnt vmcnt(13)
  v_mfma_f32_16x16x32_bf16 v[48:51], a[40:43], v[128:131], v[48:51]
  v_mfma_f32_16x16x32_bf16 v[52:55], a[44:47], v[128:131], v[52:55]
  s_add_u32 s55, s69, 4096
  buffer_load_dwordx4 v[176:179], v2, s[28:31], s55 offen offset:1024 sc1
  v_mfma_f32_16x16x32_bf16 v[56:59], a[48:51], v[128:131], v[56:59]
  v_mfma_f32_16x16x32_bf16 v[60:63], a[52:55], v[128:131], v[60:63]
  v_mfma_f32_16x16x32_bf16 v[64:67], a[56:59], v[128:131], v[64:67]
  s_waitcnt vmcnt(13)
  v_mfma_f32_16x16x32_bf16 v[68:71], a[40:43], v[132:135], v[68:71]
  v_mfma_f32_16x16x32_bf16 v[72:75], a[44:47], v[132:135], v[72:75]
  s_add_u32 s55, s67, 4096
  buffer_load_dwordx4 v[180:183], v2, s[28:31], s55 offen offset:2048 sc1
  v_mfma_f32_16x16x32_bf16 v[76:79], a[48:51], v[132:135], v[76:79]
  v_mfma_f32_16x16x32_bf16 v[80:83], a[52:55], v[132:135], v[80:83]
  v_mfma_f32_16x16x32_bf16 v[84:87], a[56:59], v[132:135], v[84:87]
  s_waitcnt vmcnt(13)
  v_mfma_f32_16x16x32_bf16 v[8:11], a[60:63], v[136:139], v[8:11]
  v_and_b32 v6, 15, v1
  v_mfma_f32_16x16x32_bf16 v[12:15], a[64:67], v[136:139], v[12:15]
  s_add_u32 s55, s68, 4096
  buffer_load_dwordx4 v[184:187], v2, s[28:31], s55 offen offset:2048 sc1
  v_mfma_f32_16x16x32_bf16 v[16:19], a[68:71], v[136:139], v[16:19]
  v_mfma_f32_16x16x32_bf16 v[20:23], a[72:75], v[136:139], v[20:23]
  v_lshrrev_b32 v7, 4, v1
  v_mfma_f32_16x16x32_bf16 v[24:27], a[76:79], v[136:139], v[24:27]
  s_waitcnt vmcnt(12)
  v_mfma_f32_16x16x32_bf16 v[28:31], a[60:63], v[140:143], v[28:31]
  v_mul_u32_u24 v6, 176, v6
  v_mfma_f32_16x16x32_bf16 v[32:35], a[64:67], v[140:143], v[32:35]
  s_add_u32 s55, s69, 4096
  buffer_load_dwordx4 v[188:191], v2, s[28:31], s55 offen offset:2048 sc1
  v_mfma_f32_16x16x32_bf16 v[36:39], a[68:71], v[140:143], v[36:39]
  v_mfma_f32_16x16x32_bf16 v[40:43], a[72:75], v[140:143], v[40:43]
  v_lshl_add_u32 v6, v7, 3, v6
  v_mfma_f32_16x16x32_bf16 v[44:47], a[76:79], v[140:143], v[44:47]
  s_waitcnt vmcnt(11)
  v_mfma_f32_16x16x32_bf16 v[48:51], a[60:63], v[144:147], v[48:51]
  s_mul_i32 s56, s48, 3072
  v_mfma_f32_16x16x32_bf16 v[52:55], a[64:67], v[144:147], v[52:55]
  s_add_u32 s55, s67, 4096
  buffer_load_dwordx4 v[192:195], v2, s[28:31], s55 offen offset:3072 sc1
  v_mfma_f32_16x16x32_bf16 v[56:59], a[68:71], v[144:147], v[56:59]
  v_mfma_f32_16x16x32_bf16 v[60:63], a[72:75], v[144:147], v[60:63]
  s_add_u32 s56, s56, 65536
  v_mfma_f32_16x16x32_bf16 v[64:67], a[76:79], v[144:147], v[64:67]
  s_waitcnt vmcnt(11)
  v_mfma_f32_16x16x32_bf16 v[68:71], a[60:63], v[148:151], v[68:71]
  v_add_u32 v6, s56, v6
  v_mfma_f32_16x16x32_bf16 v[72:75], a[64:67], v[148:151], v[72:75]
  s_add_u32 s55, s68, 4096
  buffer_load_dwordx4 v[196:199], v2, s[28:31], s55 offen offset:3072 sc1
  v_mfma_f32_16x16x32_bf16 v[76:79], a[68:71], v[148:151], v[76:79]
  v_mfma_f32_16x16x32_bf16 v[80:83], a[72:75], v[148:151], v[80:83]
  v_add_u32 v7, 0, v1
  v_mfma_f32_16x16x32_bf16 v[84:87], a[76:79], v[148:151], v[84:87]
  s_waitcnt vmcnt(11)
  v_mfma_f32_16x16x32_bf16 v[8:11], a[80:83], v[152:155], v[8:11]
  v_mul_u32_u24 v3, 6554, v7
  v_mfma_f32_16x16x32_bf16 v[12:15], a[84:87], v[152:155], v[12:15]
  s_add_u32 s55, s69, 4096
  buffer_load_dwordx4 v[88:91], v2, s[28:31], s55 offen offset:3072 sc1
  v_mfma_f32_16x16x32_bf16 v[16:19], a[88:91], v[152:155], v[16:19]
  v_mfma_f32_16x16x32_bf16 v[20:23], a[92:95], v[152:155], v[20:23]
  v_lshrrev_b32 v3, 16, v3
  v_mfma_f32_16x16x32_bf16 v[24:27], a[96:99], v[152:155], v[24:27]
  s_waitcnt vmcnt(11)
  v_mfma_f32_16x16x32_bf16 v[28:31], a[80:83], v[156:159], v[28:31]
  v_mul_u32_u24 v4, 10, v3
  v_mfma_f32_16x16x32_bf16 v[32:35], a[84:87], v[156:159], v[32:35]
  s_add_u32 s55, s67, 8192
  buffer_load_dwordx4 v[92:95], v2, s[28:31], s55 offen offset:0 sc1
  v_mfma_f32_16x16x32_bf16 v[36:39], a[88:91], v[156:159], v[36:39]
  v_mfma_f32_16x16x32_bf16 v[40:43], a[92:95], v[156:159], v[40:43]
  v_sub_u32 v4, v7, v4
  v_mfma_f32_16x16x32_bf16 v[44:47], a[96:99], v[156:159], v[44:47]
  s_waitcnt vmcnt(11)
  v_mfma_f32_16x16x32_bf16 v[48:51], a[80:83], v[160:163], v[48:51]
  v_mul_u32_u24 v7, 176, v3
  v_lshl_add_u32 v7, v4, 4, v7
  v_mfma_f32_16x16x32_bf16 v[52:55], a[84:87], v[160:163], v[52:55]
  s_add_u32 s55, s68, 8192
  buffer_load_dwordx4 v[96:99], v2, s[28:31], s55 offen offset:0 sc1
  v_mfma_f32_16x16x32_bf16 v[56:59], a[88:91], v[160:163], v[56:59]
  v_mfma_f32_16x16x32_bf16 v[60:63], a[92:95], v[160:163], v[60:63]
  v_add_u32 v7, s56, v7
  v_accvgpr_write_b32 a0, v7
  v_mfma_f32_16x16x32_bf16 v[64:67], a[96:99], v[160:163], v[64:67]
  s_waitcnt vmcnt(11)
  v_mfma_f32_16x16x32_bf16 v[68:71], a[80:83], v[164:167], v[68:71]
  v_mul_u32_u24 v7, 1280, v3
  v_lshl_add_u32 v7, v4, 4, v7
  v_mfma_f32_16x16x32_bf16 v[72:75], a[84:87], v[164:167], v[72:75]
  s_add_u32 s55, s69, 8192
  buffer_load_dwordx4 v[100:103], v2, s[28:31], s55 offen offset:0 sc1
  v_mfma_f32_16x16x32_bf16 v[76:79], a[88:91], v[164:167], v[76:79]
  v_mfma_f32_16x16x32_bf16 v[80:83], a[92:95], v[164:167], v[80:83]
  v_accvgpr_write_b32 a1, v7
  v_mfma_f32_16x16x32_bf16 v[84:87], a[96:99], v[164:167], v[84:87]
  s_waitcnt vmcnt(11)
  v_mfma_f32_16x16x32_bf16 v[28:31], a[100:103], v[168:171], v[28:31]
  v_add_u32 v7, 64, v1
  v_mfma_f32_16x16x32_bf16 v[32:35], a[104:107], v[168:171], v[32:35]
  s_add_u32 s55, s67, 8192
  buffer_load_dwordx4 v[104:107], v2, s[28:31], s55 offen offset:1024 sc1
  v_mfma_f32_16x16x32_bf16 v[36:39], a[108:111], v[168:171], v[36:39]
  v_mfma_f32_16x16x32_bf16 v[40:43], a[112:115], v[168:171], v[40:43]
  v_mul_u32_u24 v3, 6554, v7
  v_mfma_f32_16x16x32_bf16 v[44:47], a[116:119], v[168:171], v[44:47]
  s_waitcnt vmcnt(11)
  v_mfma_f32_16x16x32_bf16 v[48:51], a[100:103], v[172:175], v[48:51]
  v_lshrrev_b32 v3, 16, v3
  v_mfma_f32_16x16x32_bf16 v[52:55], a[104:107], v[172:175], v[52:55]
  s_add_u32 s55, s68, 8192
  buffer_load_dwordx4 v[108:111], v2, s[28:31], s55 offen offset:1024 sc1
  v_mfma_f32_16x16x32_bf16 v[56:59], a[108:111], v[172:175], v[56:59]
  v_mfma_f32_16x16x32_bf16 v[60:63], a[112:115], v[172:175], v[60:63]
  v_mul_u32_u24 v4, 10, v3
  v_mfma_f32_16x16x32_bf16 v[64:67], a[116:119], v[172:175], v[64:67]
  s_waitcnt vmcnt(11)
  v_mfma_f32_16x16x32_bf16 v[68:71], a[100:103], v[176:179], v[68:71]
  v_sub_u32 v4, v7, v4
  v_mfma_f32_16x16x32_bf16 v[72:75], a[104:107], v[176:179], v[72:75]
  s_add_u32 s55, s69, 8192
  buffer_load_dwordx4 v[112:115], v2, s[28:31], s55 offen offset:1024 sc1
  v_mfma_f32_16x16x32_bf16 v[76:79], a[108:111], v[176:179], v[76:79]
  v_mfma_f32_16x16x32_bf16 v[80:83], a[112:115], v[176:179], v[80:83]
  v_mul_u32_u24 v7, 176, v3
  v_lshl_add_u32 v7, v4, 4, v7
  v_mfma_f32_16x16x32_bf16 v[84:87], a[116:119], v[176:179], v[84:87]
  s_waitcnt vmcnt(11)
  v_mfma_f32_16x16x32_bf16 v[28:31], a[120:123], v[180:183], v[28:31]
  v_add_u32 v7, s56, v7
  v_accvgpr_write_b32 a2, v7
  v_mfma_f32_16x16x32_bf16 v[32:35], a[124:127], v[180:183], v[32:35]
  s_add_u32 s55, s67, 8192
  buffer_load_dwordx4 v[116:119], v2, s[28:31], s55 offen offset:2048 sc1
  v_mfma_f32_16x16x32_bf16 v[36:39], a[128:131], v[180:183], v[36:39]
  v_mfma_f32_16x16x32_bf16 v[40:43], a[132:135], v[180:183], v[40:43]
  v_mul_u32_u24 v7, 1280, v3
  v_lshl_add_u32 v7, v4, 4, v7
  v_mfma_f32_16x16x32_bf16 v[44:47], a[136:139], v[180:183], v[44:47]
  s_waitcnt vmcnt(11)
  v_mfma_f32_16x16x32_bf16 v[48:51], a[120:123], v[184:187], v[48:51]
  v_accvgpr_write_b32 a3, v7
  v_mfma_f32_16x16x32_bf16 v[52:55], a[124:127], v[184:187], v[52:55]
  s_add_u32 s55, s68, 8192
  buffer_load_dwordx4 v[120:123], v2, s[28:31], s55 offen offset:2048 sc1
  v_mfma_f32_16x16x32_bf16 v[56:59], a[128:131], v[184:187], v[56:59]
  v_mfma_f32_16x16x32_bf16 v[60:63], a[132:135], v[184:187], v[60:63]
  v_add_u32 v7, 128, v1
  v_mfma_f32_16x16x32_bf16 v[64:67], a[136:139], v[184:187], v[64:67]
  s_waitcnt vmcnt(11)
  v_mfma_f32_16x16x32_bf16 v[68:71], a[120:123], v[188:191], v[68:71]
  v_mul_u32_u24 v3, 6554, v7
  v_mfma_f32_16x16x32_bf16 v[72:75], a[124:127], v[188:191], v[72:75]
  s_add_u32 s55, s69, 8192
  buffer_load_dwordx4 v[124:127], v2, s[28:31], s55 offen offset:2048 sc1
  v_mfma_f32_16x16x32_bf16 v[76:79], a[128:131], v[188:191], v[76:79]
  v_mfma_f32_16x16x32_bf16 v[80:83], a[132:135], v[188:191], v[80:83]
  v_lshrrev_b32 v3, 16, v3
  v_mfma_f32_16x16x32_bf16 v[84:87], a[136:139], v[188:191], v[84:87]
  s_waitcnt vmcnt(11)
  v_mfma_f32_16x16x32_bf16 v[28:31], a[140:143], v[192:195], v[28:31]
  v_mul_u32_u24 v4, 10, v3
  v_mfma_f32_16x16x32_bf16 v[32:35], a[144:147], v[192:195], v[32:35]
  s_add_u32 s55, s67, 8192
  buffer_load_dwordx4 v[128:131], v2, s[28:31], s55 offen offset:3072 sc1
  v_mfma_f32_16x16x32_bf16 v[36:39], a[148:151], v[192:195], v[36:39]
  v_mfma_f32_16x16x32_bf16 v[40:43], a[152:155], v[192:195], v[40:43]
  v_sub_u32 v4, v7, v4
  v_mfma_f32_16x16x32_bf16 v[44:47], a[156:159], v[192:195], v[44:47]
  s_waitcnt vmcnt(11)
  v_mfma_f32_16x16x32_bf16 v[48:51], a[140:143], v[196:199], v[48:51]
  v_mul_u32_u24 v7, 176, v3
  v_lshl_add_u32 v7, v4, 4, v7
  v_mfma_f32_16x16x32_bf16 v[52:55], a[144:147], v[196:199], v[52:55]
  s_add_u32 s55, s68, 8192
  buffer_load_dwordx4 v[132:135], v2, s[28:31], s55 offen offset:3072 sc1
  v_mfma_f32_16x16x32_bf16 v[56:59], a[148:151], v[196:199], v[56:59]
  v_mfma_f32_16x16x32_bf16 v[60:63], a[152:155], v[196:199], v[60:63]
  v_add_u32 v7, s56, v7
  v_accvgpr_write_b32 a4, v7
  v_mfma_f32_16x16x32_bf16 v[64:67], a[156:159], v[196:199], v[64:67]
  s_waitcnt vmcnt(11)
  v_mfma_f32_16x16x32_bf16 v[68:71], a[140:143], v[88:91], v[68:71]
  v_mul_u32_u24 v7, 1280, v3
  v_lshl_add_u32 v7, v4, 4, v7
  v_mfma_f32_16x16x32_bf16 v[72:75], a[144:147], v[88:91], v[72:75]
  s_add_u32 s55, s69, 8192
  buffer_load_dwordx4 v[136:139], v2, s[28:31], s55 offen offset:3072 sc1
  v_mfma_f32_16x16x32_bf16 v[76:79], a[148:151], v[88:91], v[76:79]
  v_mfma_f32_16x16x32_bf16 v[80:83], a[152:155], v[88:91], v[80:83]
  v_accvgpr_write_b32 a5, v7
  v_mfma_f32_16x16x32_bf16 v[84:87], a[156:159], v[88:91], v[84:87]
  s_waitcnt vmcnt(11)
  v_mfma_f32_16x16x32_bf16 v[28:31], a[160:163], v[92:95], v[28:31]
  v_mfma_f32_16x16x32_bf16 v[32:35], a[164:167], v[92:95], v[32:35]
  s_add_u32 s55, s67, 12288
  buffer_load_dwordx4 v[140:143], v2, s[28:31], s55 offen offset:0 sc1
  v_mfma_f32_16x16x32_bf16 v[36:39], a[168:171], v[92:95], v[36:39]
  v_mfma_f32_16x16x32_bf16 v[40:43], a[172:175], v[92:95], v[40:43]
  v_mfma_f32_16x16x32_bf16 v[44:47], a[176:179], v[92:95], v[44:47]
  s_waitcnt vmcnt(11)
  v_mfma_f32_16x16x32_bf16 v[48:51], a[160:163], v[96:99], v[48:51]
  v_mfma_f32_16x16x32_bf16 v[52:55], a[164:167], v[96:99], v[52:55]
  s_add_u32 s55, s68, 12288
  buffer_load_dwordx4 v[144:147], v2, s[28:31], s55 offen offset:0 sc1
  v_mfma_f32_16x16x32_bf16 v[56:59], a[168:171], v[96:99], v[56:59]
  v_mfma_f32_16x16x32_bf16 v[60:63], a[172:175], v[96:99], v[60:63]
  v_mfma_f32_16x16x32_bf16 v[64:67], a[176:179], v[96:99], v[64:67]
  s_waitcnt vmcnt(11)
  v_mfma_f32_16x16x32_bf16 v[68:71], a[160:163], v[100:103], v[68:71]
  v_mfma_f32_16x16x32_bf16 v[72:75], a[164:167], v[100:103], v[72:75]
  s_add_u32 s55, s69, 12288
  buffer_load_dwordx4 v[148:151], v2, s[28:31], s55 offen offset:0 sc1
  v_mfma_f32_16x16x32_bf16 v[76:79], a[168:171], v[100:103], v[76:79]
  v_mfma_f32_16x16x32_bf16 v[80:83], a[172:175], v[100:103], v[80:83]
  v_mfma_f32_16x16x32_bf16 v[84:87], a[176:179], v[100:103], v[84:87]
  s_cmp_ge_u32 s48, 2
  s_cbranch_scc1 L_noopt_32
  s_add_u32 s99, s93, 12288
  buffer_load_dwordx4 v[220:223], v2, s[28:31], s99 offen offset:1024 sc1
  s_add_u32 s99, s93, 67584
  buffer_load_dwordx4 v[224:227], v2, s[28:31], s99 offen offset:1024 sc1
  s_add_u32 s99, s93, 122880
  buffer_load_dwordx4 v[228:231], v2, s[28:31], s99 offen offset:1024 sc1
  s_add_u32 s99, s93, 178176
  buffer_load_dwordx4 v[232:235], v2, s[28:31], s99 offen offset:1024 sc1
  s_add_u32 s99, s93, 233472
  buffer_load_dwordx4 v[236:239], v2, s[28:31], s99 offen offset:1024 sc1
  s_add_u32 s55, s66, 12288
  buffer_load_dwordx4 v[200:203], v2, s[28:31], s55 offen offset:1024 sc1
  s_add_u32 s55, s67, 12288
  buffer_load_dwordx4 v[204:207], v2, s[28:31], s55 offen offset:1024 sc1
  s_add_u32 s55, s68, 12288
  buffer_load_dwordx4 v[208:211], v2, s[28:31], s55 offen offset:1024 sc1
  s_add_u32 s55, s69, 12288
  buffer_load_dwordx4 v[212:215], v2, s[28:31], s55 offen offset:1024 sc1
L_noopt_32:
  s_waitcnt vmcnt(11)
  v_mfma_f32_16x16x32_bf16 v[28:31], a[180:183], v[104:107], v[28:31]
  v_mfma_f32_16x16x32_bf16 v[32:35], a[184:187], v[104:107], v[32:35]
  s_add_u32 s55, s66, 4096
  buffer_load_dwordx4 v[152:155], v2, s[28:31], s55 offen offset:1024 sc1
  v_mfma_f32_16x16x32_bf16 v[36:39], a[188:191], v[104:107], v[36:39]
  v_mfma_f32_16x16x32_bf16 v[40:43], a[192:195], v[104:107], v[40:43]
  v_mfma_f32_16x16x32_bf16 v[44:47], a[196:199], v[104:107], v[44:47]
  s_waitcnt vmcnt(11)
  v_mfma_f32_16x16x32_bf16 v[48:51], a[180:183], v[108:111], v[48:51]
  v_mfma_f32_16x16x32_bf16 v[52:55], a[184:187], v[108:111], v[52:55]
  s_add_u32 s55, s66, 4096
  buffer_load_dwordx4 v[156:159], v2, s[28:31], s55 offen offset:2048 sc1
  v_mfma_f32_16x16x32_bf16 v[56:59], a[188:191], v[108:111], v[56:59]
  v_mfma_f32_16x16x32_bf16 v[60:63], a[192:195], v[108:111], v[60:63]
  v_mfma_f32_16x16x32_bf16 v[64:67], a[196:199], v[108:111], v[64:67]
  s_waitcnt vmcnt(11)
  v_mfma_f32_16x16x32_bf16 v[68:71], a[180:183], v[112:115], v[68:71]
  v_mfma_f32_16x16x32_bf16 v[72:75], a[184:187], v[112:115], v[72:75]
  s_add_u32 s55, s66, 4096
  buffer_load_dwordx4 v[160:163], v2, s[28:31], s55 offen offset:3072 sc1
  v_mfma_f32_16x16x32_bf16 v[76:79], a[188:191], v[112:115], v[76:79]
  v_mfma_f32_16x16x32_bf16 v[80:83], a[192:195], v[112:115], v[80:83]
  v_mfma_f32_16x16x32_bf16 v[84:87], a[196:199], v[112:115], v[84:87]
  s_waitcnt vmcnt(11)
  v_mfma_f32_16x16x32_bf16 v[28:31], a[200:203], v[116:119], v[28:31]
  v_mfma_f32_16x16x32_bf16 v[32:35], a[204:207], v[116:119], v[32:35]
  s_add_u32 s55, s66, 8192
  buffer_load_dwordx4 v[164:167], v2, s[28:31], s55 offen offset:0 sc1
  v_mfma_f32_16x16x32_bf16 v[36:39], a[208:211], v[116:119], v[36:39]
  v_mfma_f32_16x16x32_bf16 v[40:43], a[212:215], v[116:119], v[40:43]
  v_mfma_f32_16x16x32_bf16 v[44:47], a[216:219], v[116:119], v[44:47]
  s_waitcnt vmcnt(11)
  v_mfma_f32_16x16x32_bf16 v[48:51], a[200:203], v[120:123], v[48:51]
  v_mfma_f32_16x16x32_bf16 v[52:55], a[204:207], v[120:123], v[52:55]
  s_add_u32 s55, s66, 8192
  buffer_load_dwordx4 v[168:171], v2, s[28:31], s55 offen offset:1024 sc1
  v_mfma_f32_16x16x32_bf16 v[56:59], a[208:211], v[120:123], v[56:59]
  v_mfma_f32_16x16x32_bf16 v[60:63], a[212:215], v[120:123], v[60:63]
  v_mfma_f32_16x16x32_bf16 v[64:67], a[216:219], v[120:123], v[64:67]
  s_waitcnt vmcnt(11)
  v_mfma_f32_16x16x32_bf16 v[68:71], a[200:203], v[124:127], v[68:71]
  v_mfma_f32_16x16x32_bf16 v[72:75], a[204:207], v[124:127], v[72:75]
  s_add_u32 s55, s66, 8192
  buffer_load_dwordx4 v[172:175], v2, s[28:31], s55 offen offset:2048 sc1
  v_mfma_f32_16x16x32_bf16 v[76:79], a[208:211], v[124:127], v[76:79]
  v_mfma_f32_16x16x32_bf16 v[80:83], a[212:215], v[124:127], v[80:83]
  v_mfma_f32_16x16x32_bf16 v[84:87], a[216:219], v[124:127], v[84:87]
  s_waitcnt vmcnt(11)
  v_mfma_f32_16x16x32_bf16 v[28:31], a[220:223], v[128:131], v[28:31]
  v_mfma_f32_16x16x32_bf16 v[32:35], a[224:227], v[128:131], v[32:35]
  s_add_u32 s55, s66, 8192
  buffer_load_dwordx4 v[176:179], v2, s[28:31], s55 offen offset:3072 sc1
  v_mfma_f32_16x16x32_bf16 v[36:39], a[228:231], v[128:131], v[36:39]
  v_mfma_f32_16x16x32_bf16 v[40:43], a[232:235], v[128:131], v[40:43]
  v_mfma_f32_16x16x32_bf16 v[44:47], a[236:239], v[128:131], v[44:47]
  s_waitcnt vmcnt(11)
  v_mfma_f32_16x16x32_bf16 v[48:51], a[220:223], v[132:135], v[48:51]
  v_mfma_f32_16x16x32_bf16 v[52:55], a[224:227], v[132:135], v[52:55]
  s_add_u32 s55, s66, 12288
  buffer_load_dwordx4 v[180:183], v2, s[28:31], s55 offen offset:0 sc1
  v_mfma_f32_16x16x32_bf16 v[56:59], a[228:231], v[132:135], v[56:59]
  v_mfma_f32_16x16x32_bf16 v[60:63], a[232:235], v[132:135], v[60:63]
  v_mfma_f32_16x16x32_bf16 v[64:67], a[236:239], v[132:135], v[64:67]
  s_waitcnt vmcnt(11)
  v_mfma_f32_16x16x32_bf16 v[68:71], a[220:223], v[136:139], v[68:71]
  v_mfma_f32_16x16x32_bf16 v[72:75], a[224:227], v[136:139], v[72:75]
  v_mfma_f32_16x16x32_bf16 v[76:79], a[228:231], v[136:139], v[76:79]
  v_mfma_f32_16x16x32_bf16 v[80:83], a[232:235], v[136:139], v[80:83]
  v_mfma_f32_16x16x32_bf16 v[84:87], a[236:239], v[136:139], v[84:87]
  s_waitcnt vmcnt(10)
  v_mfma_f32_16x16x32_bf16 v[28:31], a[240:243], v[140:143], v[28:31]
  v_mfma_f32_16x16x32_bf16 v[32:35], a[244:247], v[140:143], v[32:35]
  v_mfma_f32_16x16x32_bf16 v[36:39], a[248:251], v[140:143], v[36:39]
  v_mfma_f32_16x16x32_bf16 v[40:43], a[252:255], v[140:143], v[40:43]
  v_mfma_f32_16x16x32_bf16 v[44:47], v[216:219], v[140:143], v[44:47]
  s_waitcnt vmcnt(9)
  v_mfma_f32_16x16x32_bf16 v[48:51], a[240:243], v[144:147], v[48:51]
  v_mfma_f32_16x16x32_bf16 v[52:55], a[244:247], v[144:147], v[52:55]
  v_mfma_f32_16x16x32_bf16 v[56:59], a[248:251], v[144:147], v[56:59]
  v_mfma_f32_16x16x32_bf16 v[60:63], a[252:255], v[144:147], v[60:63]
  v_mfma_f32_16x16x32_bf16 v[64:67], v[216:219], v[144:147], v[64:67]
  s_waitcnt vmcnt(8)
  v_mfma_f32_16x16x32_bf16 v[68:71], a[240:243], v[148:151], v[68:71]
  v_mfma_f32_16x16x32_bf16 v[72:75], a[244:247], v[148:151], v[72:75]
  v_mfma_f32_16x16x32_bf16 v[76:79], a[248:251], v[148:151], v[76:79]
  v_mfma_f32_16x16x32_bf16 v[80:83], a[252:255], v[148:151], v[80:83]
  v_mfma_f32_16x16x32_bf16 v[84:87], v[216:219], v[148:151], v[84:87]
  s_cmp_ge_u32 s48, 2
  s_cbranch_scc1 L_opt2_33
  s_waitcnt vmcnt(8)
  v_mfma_f32_16x16x32_bf16 v[28:31], v[220:223], v[204:207], v[28:31]
  v_mfma_f32_16x16x32_bf16 v[32:35], v[224:227], v[204:207], v[32:35]
  v_mfma_f32_16x16x32_bf16 v[36:39], v[228:231], v[204:207], v[36:39]
  v_mfma_f32_16x16x32_bf16 v[40:43], v[232:235], v[204:207], v[40:43]
  v_mfma_f32_16x16x32_bf16 v[44:47], v[236:239], v[204:207], v[44:47]
  v_mfma_f32_16x16x32_bf16 v[48:51], v[220:223], v[208:211], v[48:51]
  v_mfma_f32_16x16x32_bf16 v[52:55], v[224:227], v[208:211], v[52:55]
  v_mfma_f32_16x16x32_bf16 v[56:59], v[228:231], v[208:211], v[56:59]
  v_mfma_f32_16x16x32_bf16 v[60:63], v[232:235], v[208:211], v[60:63]
  v_mfma_f32_16x16x32_bf16 v[64:67], v[236:239], v[208:211], v[64:67]
  v_mfma_f32_16x16x32_bf16 v[68:71], v[220:223], v[212:215], v[68:71]
  v_mfma_f32_16x16x32_bf16 v[72:75], v[224:227], v[212:215], v[72:75]
  v_mfma_f32_16x16x32_bf16 v[76:79], v[228:231], v[212:215], v[76:79]
  v_mfma_f32_16x16x32_bf16 v[80:83], v[232:235], v[212:215], v[80:83]
  v_mfma_f32_16x16x32_bf16 v[84:87], v[236:239], v[212:215], v[84:87]
  v_mfma_f32_16x16x32_bf16 v[8:11], v[220:223], v[200:203], v[8:11]
  v_mfma_f32_16x16x32_bf16 v[12:15], v[224:227], v[200:203], v[12:15]
  v_mfma_f32_16x16x32_bf16 v[16:19], v[228:231], v[200:203], v[16:19]
  v_mfma_f32_16x16x32_bf16 v[20:23], v[232:235], v[200:203], v[20:23]
  v_mfma_f32_16x16x32_bf16 v[24:27], v[236:239], v[200:203], v[24:27]
L_opt2_33:
  s_waitcnt vmcnt(7)
  v_mfma_f32_16x16x32_bf16 v[8:11], a[100:103], v[152:155], v[8:11]
  v_mfma_f32_16x16x32_bf16 v[12:15], a[104:107], v[152:155], v[12:15]
  v_mfma_f32_16x16x32_bf16 v[16:19], a[108:111], v[152:155], v[16:19]
  v_mfma_f32_16x16x32_bf16 v[20:23], a[112:115], v[152:155], v[20:23]
  s_nop 2
  ds_write_b128 v241, v[28:31] offset:0
  v_mfma_f32_16x16x32_bf16 v[24:27], a[116:119], v[152:155], v[24:27]
  s_waitcnt vmcnt(6)
  v_mfma_f32_16x16x32_bf16 v[8:11], a[120:123], v[156:159], v[8:11]
  ds_write_b128 v241, v[32:35] offset:1024
  v_mfma_f32_16x16x32_bf16 v[12:15], a[124:127], v[156:159], v[12:15]
  v_mfma_f32_16x16x32_bf16 v[16:19], a[128:131], v[156:159], v[16:19]
  ds_write_b128 v241, v[36:39] offset:2048
  v_mfma_f32_16x16x32_bf16 v[20:23], a[132:135], v[156:159], v[20:23]
  v_mfma_f32_16x16x32_bf16 v[24:27], a[136:139], v[156:159], v[24:27]
  ds_write_b128 v241, v[40:43] offset:3072
  s_waitcnt vmcnt(5)
  v_mfma_f32_16x16x32_bf16 v[8:11], a[140:143], v[160:163], v[8:11]
  v_mfma_f32_16x16x32_bf16 v[12:15], a[144:147], v[160:163], v[12:15]
  ds_write_b128 v241, v[44:47] offset:4096
  v_mfma_f32_16x16x32_bf16 v[16:19], a[148:151], v[160:163], v[16:19]
  v_mfma_f32_16x16x32_bf16 v[20:23], a[152:155], v[160:163], v[20:23]
  ds_write_b128 v242, v[48:51] offset:0
  v_mfma_f32_16x16x32_bf16 v[24:27], a[156:159], v[160:163], v[24:27]
  s_waitcnt vmcnt(4)
  v_mfma_f32_16x16x32_bf16 v[8:11], a[160:163], v[164:167], v[8:11]
  ds_write_b128 v242, v[52:55] offset:1024
  v_mfma_f32_16x16x32_bf16 v[12:15], a[164:167], v[164:167], v[12:15]
  v_mfma_f32_16x16x32_bf16 v[16:19], a[168:171], v[164:167], v[16:19]
  ds_write_b128 v242, v[56:59] offset:2048
  v_mfma_f32_16x16x32_bf16 v[20:23], a[172:175], v[164:167], v[20:23]
  v_mfma_f32_16x16x32_bf16 v[24:27], a[176:179], v[164:167], v[24:27]
  ds_write_b128 v242, v[60:63] offset:3072
  s_waitcnt vmcnt(3)
  v_mfma_f32_16x16x32_bf16 v[8:11], a[180:183], v[168:171], v[8:11]
  v_mfma_f32_16x16x32_bf16 v[12:15], a[184:187], v[168:171], v[12:15]
  ds_write_b128 v242, v[64:67] offset:4096
  v_mfma_f32_16x16x32_bf16 v[16:19], a[188:191], v[168:171], v[16:19]
  v_mfma_f32_16x16x32_bf16 v[20:23], a[192:195], v[168:171], v[20:23]
  ds_write_b128 v243, v[68:71] offset:0
  v_mfma_f32_16x16x32_bf16 v[24:27], a[196:199], v[168:171], v[24:27]
  s_waitcnt vmcnt(2)
  v_mfma_f32_16x16x32_bf16 v[8:11], a[200:203], v[172:175], v[8:11]
  ds_write_b128 v243, v[72:75] offset:1024
  v_mfma_f32_16x16x32_bf16 v[12:15], a[204:207], v[172:175], v[12:15]
  v_mfma_f32_16x16x32_bf16 v[16:19], a[208:211], v[172:175], v[16:19]
  ds_write_b128 v243, v[76:79] offset:2048
  v_mfma_f32_16x16x32_bf16 v[20:23], a[212:215], v[172:175], v[20:23]
  v_mfma_f32_16x16x32_bf16 v[24:27], a[216:219], v[172:175], v[24:27]
  ds_write_b128 v243, v[80:83] offset:3072
  s_waitcnt vmcnt(1)
  v_mfma_f32_16x16x32_bf16 v[8:11], a[220:223], v[176:179], v[8:11]
  v_mfma_f32_16x16x32_bf16 v[12:15], a[224:227], v[176:179], v[12:15]
  ds_write_b128 v243, v[84:87] offset:4096
  v_mfma_f32_16x16x32_bf16 v[16:19], a[228:231], v[176:179], v[16:19]
  v_mfma_f32_16x16x32_bf16 v[20:23], a[232:235], v[176:179], v[20:23]
  v_mfma_f32_16x16x32_bf16 v[24:27], a[236:239], v[176:179], v[24:27]
  s_waitcnt vmcnt(0)
  v_mfma_f32_16x16x32_bf16 v[8:11], a[240:243], v[180:183], v[8:11]
  v_mfma_f32_16x16x32_bf16 v[12:15], a[244:247], v[180:183], v[12:15]
  v_mfma_f32_16x16x32_bf16 v[16:19], a[248:251], v[180:183], v[16:19]
  v_mfma_f32_16x16x32_bf16 v[20:23], a[252:255], v[180:183], v[20:23]
  v_mfma_f32_16x16x32_bf16 v[24:27], v[216:219], v[180:183], v[24:27]
  v_accvgpr_read_b32 v154, a0
  v_accvgpr_read_b32 v158, a1
  v_accvgpr_read_b32 v155, a2
  v_accvgpr_read_b32 v159, a3
  v_accvgpr_read_b32 v156, a4
  v_accvgpr_read_b32 v160, a5
  v_lshlrev_b32 v164, 16, v246
  v_and_b32 v165, 0xffff0000, v246
  v_lshlrev_b32 v166, 16, v247
  v_and_b32 v167, 0xffff0000, v247
  v_lshlrev_b32 v168, 16, v248
  v_and_b32 v169, 0xffff0000, v248
  v_lshlrev_b32 v170, 16, v249
  v_and_b32 v171, 0xffff0000, v249
  v_lshlrev_b32 v172, 16, v250
  v_and_b32 v173, 0xffff0000, v250
  v_lshlrev_b32 v174, 16, v251
  v_and_b32 v175, 0xffff0000, v251
  v_lshlrev_b32 v176, 16, v252
  v_and_b32 v177, 0xffff0000, v252
  v_lshlrev_b32 v178, 16, v253
  v_and_b32 v179, 0xffff0000, v253
  v_lshlrev_b32 v180, 16, v254
  v_and_b32 v181, 0xffff0000, v254
  v_lshlrev_b32 v182, 16, v255
  v_and_b32 v183, 0xffff0000, v255
  v_mov_b32 v162, v5
  s_waitcnt lgkmcnt(0)
  s_barrier
  ds_read_b128 v[88:91], v240 offset:0
  ds_read_b128 v[92:95], v240 offset:1024
  ds_read_b128 v[96:99], v240 offset:2048
  ds_read_b128 v[100:103], v240 offset:3072
  ds_read_b128 v[104:107], v240 offset:4096
  ds_read_b128 v[108:111], v240 offset:5120
  ds_read_b128 v[112:115], v240 offset:6144
  ds_read_b128 v[116:119], v240 offset:7168
  ds_read_b128 v[120:123], v240 offset:8192
  ds_read_b128 v[124:127], v240 offset:9216
  ds_read_b128 v[128:131], v240 offset:10240
  ds_read_b128 v[132:135], v240 offset:11264
  ds_read_b128 v[136:139], v240 offset:12288
  ds_read_b128 v[140:143], v240 offset:13312
  ds_read_b128 v[144:147], v240 offset:14336
  s_waitcnt lgkmcnt(14)
  v_pk_add_f32 v[8:9], v[8:9], v[88:89]
  v_pk_add_f32 v[10:11], v[10:11], v[90:91]
  s_waitcnt lgkmcnt(13)
  v_pk_add_f32 v[12:13], v[12:13], v[92:93]
  v_pk_add_f32 v[14:15], v[14:15], v[94:95]
  s_waitcnt lgkmcnt(12)
  v_pk_add_f32 v[16:17], v[16:17], v[96:97]
  v_pk_add_f32 v[18:19], v[18:19], v[98:99]
  s_waitcnt lgkmcnt(11)
  v_pk_add_f32 v[20:21], v[20:21], v[100:101]
  v_pk_add_f32 v[22:23], v[22:23], v[102:103]
  s_waitcnt lgkmcnt(10)
  v_pk_add_f32 v[24:25], v[24:25], v[104:105]
  v_pk_add_f32 v[26:27], v[26:27], v[106:107]
  s_waitcnt lgkmcnt(9)
  v_pk_add_f32 v[8:9], v[8:9], v[108:109]
  v_pk_add_f32 v[10:11], v[10:11], v[110:111]
  s_waitcnt lgkmcnt(8)
  v_pk_add_f32 v[12:13], v[12:13], v[112:113]
  v_pk_add_f32 v[14:15], v[14:15], v[114:115]
  s_waitcnt lgkmcnt(7)
  v_pk_add_f32 v[16:17], v[16:17], v[116:117]
  v_pk_add_f32 v[18:19], v[18:19], v[118:119]
  s_waitcnt lgkmcnt(6)
  v_pk_add_f32 v[20:21], v[20:21], v[120:121]
  v_pk_add_f32 v[22:23], v[22:23], v[122:123]
  s_waitcnt lgkmcnt(5)
  v_pk_add_f32 v[24:25], v[24:25], v[124:125]
  v_pk_add_f32 v[26:27], v[26:27], v[126:127]
  s_waitcnt lgkmcnt(4)
  v_pk_add_f32 v[8:9], v[8:9], v[128:129]
  v_pk_add_f32 v[10:11], v[10:11], v[130:131]
  v_pk_fma_f32 v[8:9], v[8:9], v[162:163], v[164:165] op_sel_hi:[1,0,1]
  v_pk_fma_f32 v[10:11], v[10:11], v[162:163], v[166:167] op_sel_hi:[1,0,1]
  v_cvt_pk_bf16_f32 v40, v8, v9
  v_cvt_pk_bf16_f32 v41, v10, v11
  ds_write_b64 v6, v[40:41] offset:0
  s_waitcnt lgkmcnt(4)
  v_pk_add_f32 v[12:13], v[12:13], v[132:133]
  v_pk_add_f32 v[14:15], v[14:15], v[134:135]
  v_pk_fma_f32 v[12:13], v[12:13], v[162:163], v[168:169] op_sel_hi:[1,0,1]
  v_pk_fma_f32 v[14:15], v[14:15], v[162:163], v[170:171] op_sel_hi:[1,0,1]
  v_cvt_pk_bf16_f32 v42, v12, v13
  v_cvt_pk_bf16_f32 v43, v14, v15
  ds_write_b64 v6, v[42:43] offset:32
  s_waitcnt lgkmcnt(4)
  v_pk_add_f32 v[16:17], v[16:17], v[136:137]
  v_pk_add_f32 v[18:19], v[18:19], v[138:139]
  v_pk_fma_f32 v[16:17], v[16:17], v[162:163], v[172:173] op_sel_hi:[1,0,1]
  v_pk_fma_f32 v[18:19], v[18:19], v[162:163], v[174:175] op_sel_hi:[1,0,1]
  v_cvt_pk_bf16_f32 v44, v16, v17
  v_cvt_pk_bf16_f32 v45, v18, v19
  ds_write_b64 v6, v[44:45] offset:64
  s_waitcnt lgkmcnt(4)
  v_pk_add_f32 v[20:21], v[20:21], v[140:141]
  v_pk_add_f32 v[22:23], v[22:23], v[142:143]
  v_pk_fma_f32 v[20:21], v[20:21], v[162:163], v[176:177] op_sel_hi:[1,0,1]
  v_pk_fma_f32 v[22:23], v[22:23], v[162:163], v[178:179] op_sel_hi:[1,0,1]
  v_cvt_pk_bf16_f32 v46, v20, v21
  v_cvt_pk_bf16_f32 v47, v22, v23
  ds_write_b64 v6, v[46:47] offset:96
  s_waitcnt lgkmcnt(4)
  v_pk_add_f32 v[24:25], v[24:25], v[144:145]
  v_pk_add_f32 v[26:27], v[26:27], v[146:147]
  v_pk_fma_f32 v[24:25], v[24:25], v[162:163], v[180:181] op_sel_hi:[1,0,1]
  v_pk_fma_f32 v[26:27], v[26:27], v[162:163], v[182:183] op_sel_hi:[1,0,1]
  v_cvt_pk_bf16_f32 v48, v24, v25
  v_cvt_pk_bf16_f32 v49, v26, v27
  ds_write_b64 v6, v[48:49] offset:128
  s_waitcnt lgkmcnt(0)
  ds_read_b128 v[52:55], v154
  ds_read_b128 v[56:59], v155
  ds_read_b128 v[60:63], v156
  s_waitcnt lgkmcnt(2)
  buffer_store_dwordx4 v[52:55], v158, s[36:39], s60 offen
  s_waitcnt lgkmcnt(1)
  buffer_store_dwordx4 v[56:59], v159, s[36:39], s60 offen
  s_waitcnt lgkmcnt(0)
  s_mov_b64 exec, 0xffffffff
  buffer_store_dwordx4 v[60:63], v160, s[36:39], s60 offen
  s_mov_b64 exec, -1
  s_or_b32 s55, s2, s48
  s_cmp_lg_u32 s55, 0
  s_cbranch_scc1 L_ep_39
  v_mov_b32 v6, 0
  v_mov_b32 v7, s51
  s_mov_b32 s58, 24358912
  s_mov_b64 exec, 1
  buffer_store_dword v7, v6, s[28:31], s58 offen sc1
  s_mov_b64 exec, -1
L_ep_39:
L_exit:
  s_endpgm
L_smx:
  s_nop 1
  v_mfma_f32_32x32x16_bf16 v[124:139], v[8:11], v[112:115], 0
  v_mfma_f32_32x32x16_bf16 v[124:139], v[12:15], v[116:119], v[124:139]
  v_mfma_f32_32x32x16_bf16 v[124:139], v[16:19], v[120:123], v[124:139]
  v_mfma_f32_32x32x16_bf16 v[140:155], v[20:23], v[112:115], 0
  v_mfma_f32_32x32x16_bf16 v[140:155], v[24:27], v[116:119], v[140:155]
  v_mfma_f32_32x32x16_bf16 v[140:155], v[28:31], v[120:123], v[140:155]
  s_mov_b32 m0, s89
  s_nop 0
  buffer_load_dwordx4 v2, s[44:47], s89 offen sc1 lds
  s_add_u32 s89, s89, 4096
  s_nop 4
  v_max3_f32 v218, v124, v125, v126
  v_min3_f32 v222, v124, v125, v126
  v_max3_f32 v219, v128, v129, v130
  v_min3_f32 v223, v128, v129, v130
  v_max3_f32 v220, v132, v133, v134
  v_min3_f32 v224, v132, v133, v134
  v_max3_f32 v221, v136, v137, v138
  v_min3_f32 v225, v136, v137, v138
  v_max3_f32 v218, v218, v127, v140
  v_min3_f32 v222, v222, v127, v140
  v_max3_f32 v219, v219, v131, v141
  v_min3_f32 v223, v223, v131, v141
  s_mov_b32 m0, s89
  v_max3_f32 v220, v220, v135, v142
  buffer_load_dwordx4 v2, s[44:47], s89 offen sc1 lds
  s_add_u32 s89, s89, 4096
  v_min3_f32 v224, v224, v135, v142
  v_max3_f32 v221, v221, v139, v143
  v_min3_f32 v225, v225, v139, v143
  v_max3_f32 v218, v218, v219, v220
  v_min3_f32 v222, v222, v223, v224
  v_max_f32 v218, v218, v221
  v_min_f32 v222, v222, v225
  v_mul_f32 v226, v232, v218
  v_mul_f32 v228, v232, v222
  v_pk_fma_f32 v[156:157], v[124:125], v[232:233], v[226:227] op_sel_hi:[1,0,0] neg_lo:[0,0,1] neg_hi:[0,0,1]
  v_pk_fma_f32 v[158:159], v[126:127], v[232:233], v[226:227] op_sel_hi:[1,0,0] neg_lo:[0,0,1] neg_hi:[0,0,1]
  v_pk_fma_f32 v[160:161], v[128:129], v[232:233], v[226:227] op_sel_hi:[1,0,0] neg_lo:[0,0,1] neg_hi:[0,0,1]
  s_mov_b32 m0, s89
  v_pk_fma_f32 v[162:163], v[130:131], v[232:233], v[226:227] op_sel_hi:[1,0,0] neg_lo:[0,0,1] neg_hi:[0,0,1]
  buffer_load_dwordx4 v2, s[44:47], s89 offen sc1 lds
  s_add_u32 s89, s89, 4096
  v_pk_fma_f32 v[164:165], v[132:133], v[232:233], v[226:227] op_sel_hi:[1,0,0] neg_lo:[0,0,1] neg_hi:[0,0,1]
  v_pk_fma_f32 v[166:167], v[134:135], v[232:233], v[226:227] op_sel_hi:[1,0,0] neg_lo:[0,0,1] neg_hi:[0,0,1]
  v_pk_fma_f32 v[168:169], v[136:137], v[232:233], v[226:227] op_sel_hi:[1,0,0] neg_lo:[0,0,1] neg_hi:[0,0,1]
  v_pk_fma_f32 v[170:171], v[138:139], v[232:233], v[226:227] op_sel_hi:[1,0,0] neg_lo:[0,0,1] neg_hi:[0,0,1]
  v_pk_fma_f32 v[172:173], v[140:141], v[232:233], v[226:227] op_sel_hi:[1,0,0] neg_lo:[0,0,1] neg_hi:[0,0,1]
  v_pk_fma_f32 v[174:175], v[142:143], v[232:233], v[226:227] op_sel_hi:[1,0,0] neg_lo:[0,0,1] neg_hi:[0,0,1]
  v_pk_fma_f32 v[176:177], v[124:125], v[232:233], v[228:229] op_sel_hi:[1,0,0] neg_lo:[1,0,0] neg_hi:[1,0,0]
  v_pk_fma_f32 v[178:179], v[126:127], v[232:233], v[228:229] op_sel_hi:[1,0,0] neg_lo:[1,0,0] neg_hi:[1,0,0]
  v_pk_fma_f32 v[180:181], v[128:129], v[232:233], v[228:229] op_sel_hi:[1,0,0] neg_lo:[1,0,0] neg_hi:[1,0,0]
  v_pk_fma_f32 v[182:183], v[130:131], v[232:233], v[228:229] op_sel_hi:[1,0,0] neg_lo:[1,0,0] neg_hi:[1,0,0]
  v_pk_fma_f32 v[184:185], v[132:133], v[232:233], v[228:229] op_sel_hi:[1,0,0] neg_lo:[1,0,0] neg_hi:[1,0,0]
  v_pk_fma_f32 v[186:187], v[134:135], v[232:233], v[228:229] op_sel_hi:[1,0,0] neg_lo:[1,0,0] neg_hi:[1,0,0]
  s_mov_b32 m0, s89
  v_pk_fma_f32 v[188:189], v[136:137], v[232:233], v[228:229] op_sel_hi:[1,0,0] neg_lo:[1,0,0] neg_hi:[1,0,0]
  buffer_load_dwordx4 v2, s[44:47], s89 offen sc1 lds
  s_add_u32 s89, s89, 4096
  v_pk_fma_f32 v[190:191], v[138:139], v[232:233], v[228:229] op_sel_hi:[1,0,0] neg_lo:[1,0,0] neg_hi:[1,0,0]
  v_pk_fma_f32 v[192:193], v[140:141], v[232:233], v[228:229] op_sel_hi:[1,0,0] neg_lo:[1,0,0] neg_hi:[1,0,0]
  v_pk_fma_f32 v[194:195], v[142:143], v[232:233], v[228:229] op_sel_hi:[1,0,0] neg_lo:[1,0,0] neg_hi:[1,0,0]
  v_exp_f32 v156, v156
  v_exp_f32 v157, v157
  v_exp_f32 v158, v158
  v_exp_f32 v159, v159
  v_exp_f32 v160, v160
  v_exp_f32 v161, v161
  v_exp_f32 v162, v162
  v_exp_f32 v163, v163
  v_exp_f32 v164, v164
  s_mov_b32 m0, s89
  v_exp_f32 v165, v165
  buffer_load_dwordx4 v2, s[44:47], s89 offen sc1 lds
  s_add_u32 s89, s89, 4096
  v_exp_f32 v166, v166
  v_exp_f32 v167, v167
  v_exp_f32 v168, v168
  v_exp_f32 v169, v169
  v_exp_f32 v170, v170
  v_exp_f32 v171, v171
  v_exp_f32 v172, v172
  v_exp_f32 v173, v173
  v_exp_f32 v174, v174
  v_exp_f32 v175, v175
  v_exp_f32 v176, v176
  v_exp_f32 v177, v177
  s_mov_b32 m0, s89
  v_exp_f32 v178, v178
  buffer_load_dwordx4 v2, s[44:47], s89 offen sc1 lds
  s_add_u32 s89, s89, 4096
  v_exp_f32 v179, v179
  v_exp_f32 v180, v180
  v_exp_f32 v181, v181
  v_exp_f32 v182, v182
  v_exp_f32 v183, v183
  v_exp_f32 v184, v184
  v_exp_f32 v185, v185
  v_exp_f32 v186, v186
  v_exp_f32 v187, v187
  v_exp_f32 v188, v188
  v_exp_f32 v189, v189
  v_exp_f32 v190, v190
  s_mov_b32 m0, s89
  v_exp_f32 v191, v191
  buffer_load_dwordx4 v2, s[44:47], s89 offen sc1 lds
  s_add_u32 s89, s89, 4096
  v_exp_f32 v192, v192
  v_exp_f32 v193, v193
  v_exp_f32 v194, v194
  v_exp_f32 v195, v195
  v_pk_add_f32 v[218:219], v[156:157], v[158:159]
  v_pk_add_f32 v[220:221], v[160:161], v[162:163]
  v_pk_add_f32 v[222:223], v[164:165], v[166:167]
  v_pk_add_f32 v[224:225], v[176:177], v[178:179]
  v_pk_add_f32 v[226:227], v[180:181], v[182:183]
  v_pk_add_f32 v[228:229], v[184:185], v[186:187]
  v_pk_add_f32 v[218:219], v[218:219], v[168:169]
  v_pk_add_f32 v[220:221], v[220:221], v[170:171]
  s_mov_b32 m0, s89
  v_pk_add_f32 v[222:223], v[222:223], v[172:173]
  buffer_load_dwordx4 v2, s[44:47], s89 offen sc1 lds
  s_add_u32 s89, s89, 4096
  v_pk_add_f32 v[224:225], v[224:225], v[188:189]
  v_pk_add_f32 v[226:227], v[226:227], v[190:191]
  v_pk_add_f32 v[228:229], v[228:229], v[192:193]
  v_pk_add_f32 v[218:219], v[218:219], v[174:175]
  v_pk_add_f32 v[220:221], v[220:221], v[222:223]
  v_pk_add_f32 v[224:225], v[224:225], v[194:195]
  v_pk_add_f32 v[226:227], v[226:227], v[228:229]
  v_pk_add_f32 v[218:219], v[218:219], v[220:221]
  v_pk_add_f32 v[224:225], v[224:225], v[226:227]
  v_add_f32 v218, v218, v219
  v_add_f32 v224, v224, v225
  v_rcp_f32 v218, v218
  s_mov_b32 m0, s89
  v_rcp_f32 v224, v224
  buffer_load_dwordx4 v2, s[44:47], s89 offen sc1 lds
  s_add_u32 s89, s89, 4096
  v_pk_mul_f32 v[156:157], v[156:157], v[218:219] op_sel_hi:[1,0]
  v_pk_mul_f32 v[158:159], v[158:159], v[218:219] op_sel_hi:[1,0]
  v_pk_mul_f32 v[160:161], v[160:161], v[218:219] op_sel_hi:[1,0]
  v_pk_mul_f32 v[162:163], v[162:163], v[218:219] op_sel_hi:[1,0]
  v_pk_mul_f32 v[164:165], v[164:165], v[218:219] op_sel_hi:[1,0]
  v_pk_mul_f32 v[166:167], v[166:167], v[218:219] op_sel_hi:[1,0]
  v_pk_mul_f32 v[168:169], v[168:169], v[218:219] op_sel_hi:[1,0]
  v_pk_mul_f32 v[170:171], v[170:171], v[218:219] op_sel_hi:[1,0]
  v_pk_mul_f32 v[172:173], v[172:173], v[218:219] op_sel_hi:[1,0]
  v_pk_mul_f32 v[174:175], v[174:175], v[218:219] op_sel_hi:[1,0]
  v_pk_mul_f32 v[176:177], v[176:177], v[224:225] op_sel_hi:[1,0]
  v_pk_mul_f32 v[178:179], v[178:179], v[224:225] op_sel_hi:[1,0]
  s_mov_b32 m0, s89
  v_pk_mul_f32 v[180:181], v[180:181], v[224:225] op_sel_hi:[1,0]
  buffer_load_dwordx4 v2, s[44:47], s89 offen sc1 lds
  s_add_u32 s89, s89, 4096
  v_pk_mul_f32 v[182:183], v[182:183], v[224:225] op_sel_hi:[1,0]
  v_pk_mul_f32 v[184:185], v[184:185], v[224:225] op_sel_hi:[1,0]
  v_pk_mul_f32 v[186:187], v[186:187], v[224:225] op_sel_hi:[1,0]
  v_pk_mul_f32 v[188:189], v[188:189], v[224:225] op_sel_hi:[1,0]
  v_pk_mul_f32 v[190:191], v[190:191], v[224:225] op_sel_hi:[1,0]
  v_pk_mul_f32 v[192:193], v[192:193], v[224:225] op_sel_hi:[1,0]
  v_pk_mul_f32 v[194:195], v[194:195], v[224:225] op_sel_hi:[1,0]
  v_cvt_pk_bf16_f32 v196, v156, v157
  v_cvt_pk_bf16_f32 v197, v158, v159
  v_cvt_pk_bf16_f32 v198, v160, v161
  v_cvt_pk_bf16_f32 v199, v162, v163
  v_cvt_pk_bf16_f32 v200, v164, v165
  s_mov_b32 m0, s89
  v_cvt_pk_bf16_f32 v201, v166, v167
  buffer_load_dwordx4 v2, s[44:47], s89 offen sc1 lds
  s_add_u32 s89, s89, 4096
  v_cvt_pk_bf16_f32 v202, v168, v169
  v_cvt_pk_bf16_f32 v203, v170, v171
  v_cvt_pk_bf16_f32 v204, v172, v173
  v_cvt_pk_bf16_f32 v205, v174, v175
  v_cvt_pk_bf16_f32 v206, v176, v177
  v_cvt_pk_bf16_f32 v207, v178, v179
  v_cvt_pk_bf16_f32 v208, v180, v181
  v_cvt_pk_bf16_f32 v209, v182, v183
  v_cvt_pk_bf16_f32 v210, v184, v185
  v_cvt_pk_bf16_f32 v211, v186, v187
  v_cvt_pk_bf16_f32 v212, v188, v189
  v_cvt_pk_bf16_f32 v213, v190, v191
  s_mov_b32 m0, s89
  v_cvt_pk_bf16_f32 v214, v192, v193
  buffer_load_dwordx4 v2, s[44:47], s89 offen sc1 lds
  s_add_u32 s89, s89, 4096
  v_cvt_pk_bf16_f32 v215, v194, v195
  s_setpc_b64 s[80:81]
L_end:
.section .rodata,"a"
.p2align 6
.amdhsa_kernel sequential_preLN__linear_kernel_hedgehog__dense_activation_relu__prompt_kernel
.amdhsa_next_free_vgpr 512
.amdhsa_next_free_sgpr 102
.amdhsa_accum_offset 256
.amdhsa_group_segment_fixed_size 0
.amdhsa_kernarg_size 80
.amdhsa_user_sgpr_count 2
.amdhsa_user_sgpr_kernarg_segment_ptr 1
.amdhsa_system_sgpr_workgroup_id_x 1
.end_amdhsa_kernel
```
